```python
import torch

def _softmax(x, axis=-1):
    return torch.softmax(x, dim=axis)

def _gelu(x):
    return torch.nn.functional.gelu(x, approximate='tanh')

def _silu(x):
    return torch.nn.functional.silu(x)

def _sigmoid(x):
    return torch.sigmoid(x)

def _layernorm(x, axis=-1, eps=1e-05):
    m = x.mean(dim=axis, keepdim=True)
    v = x.var(dim=axis, keepdim=True, unbiased=False)
    return (x - m) / torch.sqrt(v + eps)

def _scatter_add(tgt, idx, src, axis=0):
    return tgt.clone().index_add_(axis, idx, src)

def _segment_sum(src, seg, n):
    out = torch.zeros((n,) + src.shape[1:], dtype=src.dtype)
    return out.index_add_(0, seg, src)

def _pad(x, pw):
    flat = tuple((v for pair in reversed(pw) for v in pair))
    return torch.nn.functional.pad(x, flat)
kernel_name = 'adaLN_cond__gqa_block_cached__glu_gated_bilinear__decode'

def setup_inputs():

    _w = lambda a: (lambda t: t.to(torch.bfloat16) if t.is_floating_point() else t)(torch.as_tensor(a))

    def _A_setup():
        B, Sq, D = (1, 1, 512)
        Hq, Hkv, Sk, Dh = (32, 32, 4096, 128)
        assert Hq % Hkv == 0, (Hq, Hkv)
        return {'x': _w((lambda *s: torch.randn(*s, dtype=torch.bfloat16) * 0.05)(B, Sq, D)), 'k_cache': _w((lambda *s: torch.randn(*s, dtype=torch.bfloat16) * 0.8)(B, Hkv, Sk, Dh)), 'v_cache': _w((lambda *s: torch.randn(*s, dtype=torch.bfloat16) * 3.2)(B, Hkv, Sk, Dh)), 'wq': _w((lambda *s: torch.randn(*s, dtype=torch.bfloat16) * 0.8)(D, Hq * Dh) * D ** (-0.5)), 'wo': _w((lambda *s: torch.randn(*s, dtype=torch.bfloat16) * 3.2)(Hq * Dh, D) * (Hq * Dh) ** (-0.5))}
    _A_in = _A_setup()

    def _B_setup():
        B, S, D, F = (1, 1, 512, 1376)
        return {'x': _w((lambda *s: torch.randn(*s, dtype=torch.bfloat16) * 0.05)(B, S, D)), 'w_gate': _w((lambda *s: torch.randn(*s, dtype=torch.bfloat16) * 3.2)(D, F) * D ** (-0.5)), 'w_up': _w((lambda *s: torch.randn(*s, dtype=torch.bfloat16) * 3.2)(D, F) * D ** (-0.5)), 'w_down': _w((lambda *s: torch.randn(*s, dtype=torch.bfloat16) * 3.2)(F, D) * F ** (-0.5))}
    _B_in = _B_setup()
    return {'A_x': _A_in['x'], 'A_k_cache': _A_in['k_cache'], 'A_v_cache': _A_in['v_cache'], 'A_wq': _A_in['wq'], 'A_wo': _A_in['wo'], 'B_x': _B_in['x'], 'B_w_gate': _B_in['w_gate'], 'B_w_up': _B_in['w_up'], 'B_w_down': _B_in['w_down'], 'c': _w((lambda *s: torch.randn(*s, dtype=torch.bfloat16) * 0.4)(1, 512) * 8.0), 'w_mod': _w((lambda *s: torch.randn(*s, dtype=torch.bfloat16) * 0.4)(512, 6 * 512) * 512 ** (-0.5) * 8.0)}

def reference(A_x, A_k_cache, A_v_cache, A_wq, A_wo, B_x, B_w_gate, B_w_up, B_w_down, c, w_mod):

    def _A_ref(x, k_cache, v_cache, wq, wo):
        B, Sq, D = x.shape
        Hq, Dh = (32, 128)
        Hkv = k_cache.shape[1]
        rep = Hq // Hkv
        q = (lambda x, *d: x.permute(*d))((x @ wq).reshape(B, Sq, Hq, Dh), 0, 2, 1, 3)
        k = (lambda x, n, axis: torch.repeat_interleave(x, n, dim=axis))(k_cache, rep, axis=1)
        v = (lambda x, n, axis: torch.repeat_interleave(x, n, dim=axis))(v_cache, rep, axis=1)
        scores = torch.einsum('bhqd,bhkd->bhqk', q, k) * Dh ** (-0.5)
        p = _softmax(scores, axis=-1)
        o = torch.einsum('bhqk,bhkd->bhqd', p, v)
        return (lambda x, *d: x.permute(*d))(o, 0, 2, 1, 3).reshape(B, Sq, Hq * Dh) @ wo

    def _B_ref(x, w_gate, w_up, w_down):
        g = torch.einsum('bsd,df->bsf', x, w_gate)
        u = torch.einsum('bsd,df->bsf', x, w_up)
        h = g * u
        return torch.einsum('bsf,fd->bsd', h, w_down)
    x = A_x
    mod = (_silu(c) @ w_mod).reshape(c.shape[0], 6, 1, -1)
    sa, ca, ga, sb, cb, gb = (mod[:, 0].clone(), mod[:, 1].clone(), mod[:, 2].clone(), mod[:, 3].clone(), mod[:, 4].clone(), mod[:, 5].clone())
    h = _layernorm(x, axis=-1) * (1 + ca) + sa
    x = x + ga * _A_ref(h, A_k_cache, A_v_cache, A_wq, A_wo)
    h = _layernorm(x, axis=-1) * (1 + cb) + sb
    x = x + gb * _B_ref(h, B_w_gate, B_w_up, B_w_down)
    return x
```

```asm
; @launch grid=(256,1,1) block=(1024,1,1) lds=112384
.amdgcn_target "amdgcn-amd-amdhsa--gfx950"
.text
.p2align 12
.globl adaLN_cond__gqa_block_cached__glu_gated_bilinear__decode_kernel
.p2align 8
.type adaLN_cond__gqa_block_cached__glu_gated_bilinear__decode_kernel,@function
adaLN_cond__gqa_block_cached__glu_gated_bilinear__decode_kernel:
    s_load_dwordx8 s[16:23], s[0:1], 0
    s_load_dwordx8 s[36:43], s[0:1], 80
    s_load_dwordx2 s[34:35], s[0:1], 72
    s_cmp_ge_u32 s2, 256
    s_cbranch_scc1 Lexit
    v_cmp_gt_u32 vcc, 0x100, v0
    s_and_b32 s62, s2, 7
    s_lshr_b32 s63, s2, 3
    s_lshl_b32 s4, s62, 5
    s_add_u32 s4, s4, s63
    s_and_b32 s5, s63, 7
    s_lshr_b32 s12, s4, 3
    s_lshl_b32 s13, s62, 1
    s_and_b32 s9, s12, 1
    s_add_u32 s13, s13, s9
    s_lshr_b32 s57, s63, 4
    s_add_u32 s57, s57, s5
    v_mov_b32 v15, 107904
    s_cbranch_vccz Lrest
    v_mov_b32 v2, 0
    v_and_b32 v3, 0x7c, v0
    v_add_u32 v3, v3, v15
    ds_write_b32 v3, v2
    s_cmp_lt_u32 s57, 5
    s_cbranch_scc1 Lfirstm
    s_lshl_b32 s9, s5, 12
    s_add_u32 s9, s9, s12
    s_lshl_b32 s9, s9, 8
    s_and_b32 s9, s9, 0x3fffff
    v_lshrrev_b32 v2, 1, v0
    v_and_b32 v3, 1, v0
    v_lshl_add_u32 v2, v2, 6, v3
    v_lshl_add_u32 v2, v2, 7, s9
    s_waitcnt lgkmcnt(0)
    global_load_dword v126, v2, s[22:23]
    s_branch Lrest
Lfirstm:
    s_sub_u32 s9, 4, s5
    v_lshl_add_u32 v2, s9, 8, v0
    v_mul_u32_u24 v2, 6144, v2
    v_lshl_add_u32 v2, s13, 7, v2
    s_sub_u32 s9, s63, 3
    s_and_b32 s9, s9, 0x16
    s_waitcnt lgkmcnt(0)
    s_cbranch_scc1 Lrest
    global_load_dword v126, v2, s[36:37]
Lrest:
    s_barrier
    v_lshrrev_b32 v1, 6, v0
    v_and_b32 v0, 63, v0
    v_readfirstlane_b32 s3, v1
    s_cmp_ge_u32 s63, 16
    s_movk_i32 s9, 146
    s_cselect_b32 s14, 130, s9
    s_cmp_eq_u32 s5, 3
    s_cselect_b32 s9, s14, s9
    s_sub_u32 s14, 260, s14
    s_mul_i32 s10, s5, 146
    s_sub_u32 s10, s10, s9
    s_add_i32 s10, s10, 2
    s_mul_i32 s11, s5, 90
    s_cmp_lt_u32 s5, 3
    s_cselect_b32 s10, s11, s10
    s_cselect_b32 s9, s14, s9
    s_cmp_lt_u32 s5, 2
    s_cselect_b32 s9, 90, s9
    s_and_b32 s11, s62, 3
    s_mul_i32 s11, s11, 146
    s_add_u32 s10, s10, s11
    s_and_b32 s10, s10, 1023
    s_lshr_b32 s14, s3, 2
    s_mul_i32 s11, s14, s9
    s_add_u32 s9, s9, s11
    s_lshr_b32 s11, s11, 2
    s_lshr_b32 s9, s9, 2
    s_and_b32 s14, s3, 3
    s_add_u32 s11, s11, s14
    s_sub_u32 s8, s11, s9
    s_add_u32 s8, s8, 40
    s_and_b32 s9, s8, -4
    s_lshr_b32 s8, s8, 2
    s_sub_u32 s11, s11, s9
    s_add_u32 s10, s10, s11
    s_lshl_b32 s11, s12, 10
    s_add_u32 s10, s10, s11
    s_ashr_i32 s11, s10, 22
    s_lshl_b32 s10, s10, 10
    v_lshlrev_b32 v11, 4, v0
    v_bfe_u32 v10, v0, 2, 2
    v_lshlrev_b32 v10, 8, v10
    v_lshrrev_b32 v1, 4, v0
    v_lshl_add_u32 v10, v1, 6, v10
    v_and_b32 v1, 3, v0
    v_lshl_add_u32 v10, v1, 4, v10
    s_mov_b32 s47, 0x20000
    s_mov_b32 s46, 40960
    s_mov_b64 s[50:51], s[46:47]
    s_movk_i32 s60, 4096
    s_movk_i32 s61, 8192
    s_movk_i32 s83, 12288
    s_movk_i32 s84, 16384
    s_movk_i32 s85, 20480
    s_movk_i32 s86, 24576
    s_movk_i32 s87, 28672
    s_mov_b32 s88, 32768
    s_mov_b32 s89, 36864
    s_waitcnt lgkmcnt(0)
Lhave:
    s_add_u32 s44, s18, s10
    s_addc_u32 s45, s19, s11
    s_add_u32 s48, s20, s10
    s_addc_u32 s49, s21, s11
    s_cmp_eq_u32 s3, 5
    s_cbranch_scc1 Lreport
Lreported:
    s_cmp_lt_u32 s57, 3
    s_cbranch_scc1 Lstart
Lkv:
Lkv2:
    s_setprio 0
    s_cmp_lt_u32 s3, 8
    s_cbranch_scc1 Lkv3
    s_setprio 1
Lkv3:
    s_cmp_eq_u32 s8, 1
    s_cbranch_scc1 Lld44_1
    s_cmp_lg_u32 s8, 0
    s_cbranch_scc1 Lskip44
Lld44_0:
    buffer_load_dwordx4 v[16:19], v10, s[44:47], 0 offen offset:0 nt
Lld44_1:
    buffer_load_dwordx4 v[20:23], v10, s[44:47], s60 offen offset:0 nt
Lld44_2:
    buffer_load_dwordx4 v[24:27], v10, s[44:47], s61 offen offset:0 nt
Lld44_3:
    buffer_load_dwordx4 v[28:31], v10, s[44:47], s83 offen offset:0 nt
Lld44_4:
    buffer_load_dwordx4 v[32:35], v10, s[44:47], s84 offen offset:0 nt
Lld44_5:
    buffer_load_dwordx4 v[36:39], v10, s[44:47], s85 offen offset:0 nt
Lld44_6:
    buffer_load_dwordx4 v[40:43], v10, s[44:47], s86 offen offset:0 nt
Lld44_7:
    buffer_load_dwordx4 v[44:47], v10, s[44:47], s87 offen offset:0 nt
Lld44_8:
    buffer_load_dwordx4 v[48:51], v10, s[44:47], s88 offen offset:0 nt
Lld44_9:
    buffer_load_dwordx4 v[52:55], v10, s[44:47], s89 offen offset:0 nt
Lld44_10:
    s_setprio 0
Lkv5:
    s_mov_b32 s58, 0
    s_cmp_ge_u32 s3, 8
    s_cbranch_scc1 Lquick
Lnotquick:
    s_cmp_eq_u32 s8, 1
    s_cbranch_scc1 Lld48_1
    s_cmp_lg_u32 s8, 0
    s_cbranch_scc1 Lskip48
Lld48_0:
    buffer_load_dwordx4 v[56:59], v11, s[48:51], 0 offen offset:0 nt
Lld48_1:
    buffer_load_dwordx4 v[60:63], v11, s[48:51], s60 offen offset:0 nt
Lld48_2:
    buffer_load_dwordx4 v[64:67], v11, s[48:51], s61 offen offset:0 nt
Lld48_3:
    buffer_load_dwordx4 v[68:71], v11, s[48:51], s83 offen offset:0 nt
Lld48_4:
    buffer_load_dwordx4 v[72:75], v11, s[48:51], s84 offen offset:0 nt
Lld48_5:
    buffer_load_dwordx4 v[76:79], v11, s[48:51], s85 offen offset:0 nt
Lld48_6:
    buffer_load_dwordx4 v[80:83], v11, s[48:51], s86 offen offset:0 nt
Lld48_7:
    buffer_load_dwordx4 v[84:87], v11, s[48:51], s87 offen offset:0 nt
Lld48_8:
    buffer_load_dwordx4 v[88:91], v11, s[48:51], s88 offen offset:0 nt
Lld48_9:
    buffer_load_dwordx4 v[92:95], v11, s[48:51], s89 offen offset:0 nt
Lld48_10:
    s_branch LV0
Lstart:
    s_lshl_b32 s9, s12, 1
    s_add_u32 s9, s9, s5
    s_cmp_eq_u32 s5, 2
    s_cselect_b32 s13, s13, s9
    s_cselect_b32 s63, 1, 2
    s_sub_u32 s14, s3, 8
    s_cbranch_scc1 Llower
    s_setprio 2
    s_lshl_b32 s12, s14, 13
    s_mov_b32 s55, 0x20000
    s_cmp_eq_u32 s63, 1
    s_cselect_b64 s[52:53], s[36:37], s[22:23]
    s_cselect_b64 s[56:57], s[34:35], s[16:17]
    s_cselect_b32 s62, 6144, s61
    s_lshl_b32 s54, s62, 9
    global_load_dwordx4 v[52:55], v11, s[56:57]
    v_bfe_u32 v12, v0, 4, 1
    v_bfe_u32 v1, v0, 5, 1
    v_lshl_add_u32 v12, v12, 1, v1
    v_and_b32 v1, 15, v0
    v_lshl_add_u32 v12, v1, 2, v12
    s_lshl_b32 s9, s14, 6
    v_add_u32 v12, s9, v12
    v_cmp_gt_u32 vcc, 32, v0
    s_nop 1
    v_cndmask_b32 v7, 0, 16, vcc
    v_lshlrev_b32 v6, 1, v12
    global_load_ushort v56, v6, s[56:57]
    v_bfe_u32 v8, v0, 3, 1
    v_bfe_u32 v1, v0, 4, 1
    v_lshl_add_u32 v8, v8, 1, v1
    v_lshrrev_b32 v1, 5, v0
    v_lshl_add_u32 v8, v1, 2, v8
    v_mul_u32_u24 v8, s62, v8
    v_lshlrev_b32 v1, 1, v1
    v_and_b32 v9, 7, v0
    v_xor_b32 v1, v1, v9
    v_lshl_add_u32 v8, v1, 4, v8
    v_xor_b32 v9, 64, v8
    s_lshl_b32 s62, s62, 3
    s_mul_i32 s11, s12, s62
    s_lshr_b32 s11, s11, 10
    s_lshl_b32 s9, s13, 7
    s_add_u32 s11, s11, s9
    s_add_u32 m0, s12, 0
    s_nop 0
    buffer_load_dwordx4 v8, s[52:55], s11 offen  lds
    s_add_u32 s11, s11, s62
    s_add_u32 m0, s12, 1024
    s_nop 0
    buffer_load_dwordx4 v9, s[52:55], s11 offen  lds
    s_add_u32 s11, s11, s62
    s_add_u32 m0, s12, 2048
    s_nop 0
    buffer_load_dwordx4 v8, s[52:55], s11 offen  lds
    s_add_u32 s11, s11, s62
    s_add_u32 m0, s12, 3072
    s_nop 0
    buffer_load_dwordx4 v9, s[52:55], s11 offen  lds
    s_add_u32 s11, s11, s62
    s_add_u32 m0, s12, 4096
    s_nop 0
    buffer_load_dwordx4 v8, s[52:55], s11 offen  lds
    s_add_u32 s11, s11, s62
    s_add_u32 m0, s12, 5120
    s_nop 0
    buffer_load_dwordx4 v9, s[52:55], s11 offen  lds
    s_add_u32 s11, s11, s62
    s_add_u32 m0, s12, 6144
    s_nop 0
    buffer_load_dwordx4 v8, s[52:55], s11 offen  lds
    s_add_u32 s11, s11, s62
    s_add_u32 m0, s12, 7168
    s_nop 0
    buffer_load_dwordx4 v9, s[52:55], s11 offen  lds
    s_add_u32 s11, s11, s62
    s_branch Lworker
Lskip44:
    s_cmp_eq_u32 s8, 2
    s_cbranch_scc1 Lld44_2
    s_cmp_eq_u32 s8, 3
    s_cbranch_scc1 Lld44_3
    s_cmp_eq_u32 s8, 4
    s_cbranch_scc1 Lld44_4
    s_cmp_eq_u32 s8, 5
    s_cbranch_scc1 Lld44_5
    s_cmp_eq_u32 s8, 6
    s_cbranch_scc1 Lld44_6
    s_cmp_eq_u32 s8, 7
    s_cbranch_scc1 Lld44_7
    s_cmp_eq_u32 s8, 8
    s_cbranch_scc1 Lld44_8
    s_cmp_eq_u32 s8, 9
    s_cbranch_scc1 Lld44_9
    s_branch Lld44_10
Lskip48:
    s_cmp_eq_u32 s8, 2
    s_cbranch_scc1 Lld48_2
    s_cmp_eq_u32 s8, 3
    s_cbranch_scc1 Lld48_3
    s_cmp_eq_u32 s8, 4
    s_cbranch_scc1 Lld48_4
    s_cmp_eq_u32 s8, 5
    s_cbranch_scc1 Lld48_5
    s_cmp_eq_u32 s8, 6
    s_cbranch_scc1 Lld48_6
    s_cmp_eq_u32 s8, 7
    s_cbranch_scc1 Lld48_7
    s_cmp_eq_u32 s8, 8
    s_cbranch_scc1 Lld48_8
    s_cmp_eq_u32 s8, 9
    s_cbranch_scc1 Lld48_9
    s_branch Lld48_10
LV0:
    s_setprio 0
    s_mov_b64 exec, 1
    v_mov_b32 v1, 1
    ds_add_u32 v15, v1 offset:4
    s_mov_b64 exec, -1
LafterV:
    s_cmp_gt_u32 s8, 0
    s_cbranch_scc0 Lzeroed
    v_mov_b64 v[16:17], 0
    v_mov_b64 v[18:19], 0
    v_mov_b64 v[56:57], 0
    v_mov_b64 v[58:59], 0
    s_cmp_gt_u32 s8, 1
    s_cbranch_scc0 Lzeroed
    v_mov_b64 v[20:21], 0
    v_mov_b64 v[22:23], 0
    v_mov_b64 v[60:61], 0
    v_mov_b64 v[62:63], 0
    s_cmp_gt_u32 s8, 2
    s_cbranch_scc0 Lzeroed
    v_mov_b64 v[24:25], 0
    v_mov_b64 v[26:27], 0
    v_mov_b64 v[64:65], 0
    v_mov_b64 v[66:67], 0
    s_cmp_gt_u32 s8, 3
    s_cbranch_scc0 Lzeroed
    v_mov_b64 v[28:29], 0
    v_mov_b64 v[30:31], 0
    v_mov_b64 v[68:69], 0
    v_mov_b64 v[70:71], 0
    s_cmp_gt_u32 s8, 4
    s_cbranch_scc0 Lzeroed
    v_mov_b64 v[32:33], 0
    v_mov_b64 v[34:35], 0
    v_mov_b64 v[72:73], 0
    v_mov_b64 v[74:75], 0
    s_cmp_gt_u32 s8, 5
    s_cbranch_scc0 Lzeroed
    v_mov_b64 v[36:37], 0
    v_mov_b64 v[38:39], 0
    v_mov_b64 v[76:77], 0
    v_mov_b64 v[78:79], 0
    s_cmp_gt_u32 s8, 6
    s_cbranch_scc0 Lzeroed
    v_mov_b64 v[40:41], 0
    v_mov_b64 v[42:43], 0
    v_mov_b64 v[80:81], 0
    v_mov_b64 v[82:83], 0
    s_cmp_gt_u32 s8, 7
    s_cbranch_scc0 Lzeroed
    v_mov_b64 v[44:45], 0
    v_mov_b64 v[46:47], 0
    v_mov_b64 v[84:85], 0
    v_mov_b64 v[86:87], 0
    s_cmp_gt_u32 s8, 8
    s_cbranch_scc0 Lzeroed
    v_mov_b64 v[48:49], 0
    v_mov_b64 v[50:51], 0
    v_mov_b64 v[88:89], 0
    v_mov_b64 v[90:91], 0
    s_cmp_gt_u32 s8, 9
    s_cbranch_scc0 Lzeroed
    v_mov_b64 v[52:53], 0
    v_mov_b64 v[54:55], 0
    v_mov_b64 v[92:93], 0
    v_mov_b64 v[94:95], 0
Lzeroed:
    v_mov_b32 v12, 0
    s_load_dwordx8 s[24:31], s[0:1], 32
    s_load_dwordx2 s[32:33], s[0:1], 64
    s_load_dword s7, s[42:43], 0
    s_waitcnt lgkmcnt(0)
    s_add_u32 s7, s7, 1
    s_cmp_lt_u32 s3, 4
    s_cbranch_scc0 Lqwait
    s_cmp_eq_u32 s3, 3
    s_cbranch_scc1 Lcheck
Lnoss:
    s_mov_b64 exec, 0
    s_cmp_eq_u32 s3, 0
    s_cbranch_scc1 Lpad_M_0
    s_cmp_eq_u32 s3, 1
    s_cbranch_scc1 Lpad_M_1
    s_cmp_eq_u32 s3, 2
    s_cbranch_scc1 Lpad_M_2
    s_branch Lpad_M_3
Lret_M:
    s_mov_b64 exec, -1
Lpad_M_0:
    s_cbranch_execz Lpad_M_4
    s_lshl_b32 s9, s4, 9
    s_lshl_b32 s10, s3, 7
    s_add_u32 s9, s9, s10
    s_add_u32 s9, s9, 524288
    s_add_u32 s10, s42, s9
    s_addc_u32 s11, s43, 0
    s_mov_b32 s15, 0
Lqpoll:
    s_load_dwordx16 s[64:79], s[10:11], 0 glc
    s_load_dwordx16 s[80:95], s[10:11], 64 glc
    s_waitcnt lgkmcnt(0)
    s_xor_b32 s9, s65, s7
    s_xor_b32 s13, s67, s7
    s_or_b32 s9, s9, s13
    s_xor_b32 s13, s69, s7
    s_or_b32 s9, s9, s13
    s_xor_b32 s13, s71, s7
    s_or_b32 s9, s9, s13
    s_xor_b32 s13, s73, s7
    s_or_b32 s9, s9, s13
    s_xor_b32 s13, s75, s7
    s_or_b32 s9, s9, s13
    s_xor_b32 s13, s77, s7
    s_or_b32 s9, s9, s13
    s_xor_b32 s13, s79, s7
    s_or_b32 s9, s9, s13
    s_xor_b32 s13, s81, s7
    s_or_b32 s9, s9, s13
    s_xor_b32 s13, s83, s7
    s_or_b32 s9, s9, s13
    s_xor_b32 s13, s85, s7
    s_or_b32 s9, s9, s13
    s_xor_b32 s13, s87, s7
    s_or_b32 s9, s9, s13
    s_xor_b32 s13, s89, s7
    s_or_b32 s9, s9, s13
    s_xor_b32 s13, s91, s7
    s_or_b32 s9, s9, s13
    s_xor_b32 s13, s93, s7
    s_or_b32 s9, s9, s13
    s_xor_b32 s13, s95, s7
    s_or_b32 s9, s9, s13
    s_cbranch_scc0 Lqgot
    s_add_u32 s15, s15, 1
    s_cmp_lt_u32 s15, 131072
    s_sleep 4
    s_cbranch_scc1 Lqpoll
Lqgot:
    v_writelane_b32 v1, s64, 0
    v_writelane_b32 v1, s66, 1
    v_writelane_b32 v1, s68, 2
    v_writelane_b32 v1, s70, 3
    v_writelane_b32 v1, s72, 4
    v_writelane_b32 v1, s74, 5
    v_writelane_b32 v1, s76, 6
    v_writelane_b32 v1, s78, 7
    v_writelane_b32 v1, s80, 8
    v_writelane_b32 v1, s82, 9
    v_writelane_b32 v1, s84, 10
    v_writelane_b32 v1, s86, 11
    v_writelane_b32 v1, s88, 12
    v_writelane_b32 v1, s90, 13
    v_writelane_b32 v1, s92, 14
    v_writelane_b32 v1, s94, 15
    s_lshl_b32 s9, s3, 6
    s_add_u32 s9, s9, 107648
    v_lshl_add_u32 v2, v0, 2, s9
    s_mov_b64 exec, 0xffff
    ds_write_b32 v2, v1
    s_waitcnt lgkmcnt(0)
    s_mov_b64 exec, 1
    v_mov_b32 v1, 1
    ds_add_u32 v15, v1 offset:0
    s_mov_b64 exec, -1
    s_mov_b32 s15, 0
    s_cmp_eq_u32 s3, 3
    s_cbranch_scc1 Lcheck1b
Lqwait:
    v_lshrrev_b32 v8, 4, v0
    v_and_b32 v1, 3, v0
    v_lshl_add_u32 v8, v8, 2, v1
    v_lshlrev_b32 v8, 4, v8
    v_add_u32 v8, 107648, v8
    v_bfe_u32 v9, v0, 2, 2
    s_mov_b32 s62, 0xaaaaaaaa
    s_mov_b32 s63, 0xaaaaaaaa
    s_mov_b32 s12, 0xcccccccc
    s_mov_b32 s13, 0xcccccccc
    s_mov_b32 s15, 0
Lw_1:
    ds_read_b32 v1, v15 offset:0
    s_waitcnt lgkmcnt(0)
    v_readfirstlane_b32 s9, v1
    s_nop 0
    s_cmp_ge_u32 s9, 4
    s_cbranch_scc1 Lw_1_ok
    s_add_u32 s15, s15, 1
    s_cmp_lt_u32 s15, 524288
    s_sleep 2
    s_cbranch_scc1 Lw_1
Lw_1_ok:
    ds_read_b128 v[4:7], v8
    s_or_b32 s9, s8, s58
    s_waitcnt vmcnt(10)
    s_cmp_eq_u32 s9, 0
    s_cbranch_scc1 Lkin
    s_waitcnt vmcnt(9)
    s_cmp_eq_u32 s9, 1
    s_cbranch_scc1 Lkin
    s_waitcnt vmcnt(8)
    s_cmp_eq_u32 s9, 2
    s_cbranch_scc1 Lkin
    s_waitcnt vmcnt(7)
    s_cmp_eq_u32 s9, 3
    s_cbranch_scc1 Lkin
    s_waitcnt vmcnt(6)
    s_cmp_eq_u32 s9, 4
Lpad_M_1:
    s_cbranch_execz Lpad_M_5
    s_cbranch_scc1 Lkin
    s_waitcnt vmcnt(5)
    s_cmp_eq_u32 s9, 5
    s_cbranch_scc1 Lkin
    s_waitcnt vmcnt(4)
    s_cmp_eq_u32 s9, 6
    s_cbranch_scc1 Lkin
    s_waitcnt vmcnt(3)
    s_cmp_eq_u32 s9, 7
    s_cbranch_scc1 Lkin
    s_waitcnt vmcnt(2)
    s_cmp_eq_u32 s9, 8
    s_cbranch_scc1 Lkin
    s_waitcnt vmcnt(1)
    s_cmp_eq_u32 s9, 9
    s_cbranch_scc1 Lkin
    s_waitcnt vmcnt(0)
Lkin:
    s_waitcnt lgkmcnt(0)
    v_cmp_eq_u32 vcc, 0, v9
    s_nop 1
    v_cndmask_b32 v96, 0, v4, vcc
    v_cndmask_b32 v97, 0, v5, vcc
    v_cndmask_b32 v98, 0, v6, vcc
    v_cndmask_b32 v99, 0, v7, vcc
    v_cmp_eq_u32 vcc, 1, v9
    s_nop 1
    v_cndmask_b32 v100, 0, v4, vcc
    v_cndmask_b32 v101, 0, v5, vcc
    v_cndmask_b32 v102, 0, v6, vcc
    v_cndmask_b32 v103, 0, v7, vcc
    v_cmp_eq_u32 vcc, 2, v9
    s_nop 1
    v_cndmask_b32 v104, 0, v4, vcc
    v_cndmask_b32 v105, 0, v5, vcc
    v_cndmask_b32 v106, 0, v6, vcc
    v_cndmask_b32 v107, 0, v7, vcc
    v_cmp_eq_u32 vcc, 3, v9
    s_nop 1
    v_cndmask_b32 v108, 0, v4, vcc
    v_cndmask_b32 v109, 0, v5, vcc
    v_cndmask_b32 v110, 0, v6, vcc
    v_cndmask_b32 v111, 0, v7, vcc
    v_mfma_f32_16x16x32_bf16 v[112:115], v[16:19], v[96:99], 0
    v_mfma_f32_16x16x32_bf16 v[112:115], v[20:23], v[100:103], v[112:115]
    v_mfma_f32_16x16x32_bf16 v[112:115], v[24:27], v[104:107], v[112:115]
    v_mfma_f32_16x16x32_bf16 v[112:115], v[28:31], v[108:111], v[112:115]
    v_mfma_f32_16x16x32_bf16 v[116:119], v[32:35], v[96:99], 0
    v_mfma_f32_16x16x32_bf16 v[116:119], v[36:39], v[100:103], v[116:119]
    v_mfma_f32_16x16x32_bf16 v[116:119], v[40:43], v[104:107], v[116:119]
    v_mfma_f32_16x16x32_bf16 v[116:119], v[44:47], v[108:111], v[116:119]
    v_mfma_f32_16x16x32_bf16 v[120:123], v[48:51], v[96:99], 0
    v_mfma_f32_16x16x32_bf16 v[120:123], v[52:55], v[100:103], v[120:123]
    v_and_b32 v12, 1, v0
    v_lshlrev_b32 v12, 4, v12
    v_mov_b32 v13, 0xffff
    v_lshlrev_b32 v13, v12, v13
    s_mov_b32 s64, 0x03030303
    s_mov_b32 s65, 0x03030303
    s_lshl_b64 s[66:67], s[64:65], 2
    s_lshl_b64 s[68:69], s[64:65], 4
    s_lshl_b64 s[70:71], s[64:65], 6
    v_cndmask_b32 v112, v112, v113, s[62:63]
    v_cndmask_b32 v114, v114, v115, s[62:63]
    v_cndmask_b32 v116, v116, v117, s[62:63]
    v_cndmask_b32 v118, v118, v119, s[62:63]
    v_cndmask_b32 v120, v120, v121, s[62:63]
    v_cndmask_b32 v122, v122, v123, s[62:63]
    v_cndmask_b32 v2, v112, v114, s[12:13]
    v_cndmask_b32 v3, v116, v118, s[12:13]
    v_cndmask_b32 v4, v120, v122, s[12:13]
    v_cndmask_b32 v112, 0, v13, s[64:65]
    v_cndmask_b32 v113, 0, v13, s[66:67]
    v_cndmask_b32 v114, 0, v13, s[68:69]
    v_cndmask_b32 v115, 0, v13, s[70:71]
    v_add_f32_dpp v2, v2, v2 quad_perm:[1,0,3,2] row_mask:0xf bank_mask:0xf
    v_add_f32_dpp v3, v3, v3 quad_perm:[1,0,3,2] row_mask:0xf bank_mask:0xf
    v_add_f32_dpp v4, v4, v4 quad_perm:[1,0,3,2] row_mask:0xf bank_mask:0xf
    v_add_f32_dpp v2, v2, v2 quad_perm:[2,3,0,1] row_mask:0xf bank_mask:0xf
    v_add_f32_dpp v3, v3, v3 quad_perm:[2,3,0,1] row_mask:0xf bank_mask:0xf
    v_add_f32_dpp v4, v4, v4 quad_perm:[2,3,0,1] row_mask:0xf bank_mask:0xf
    v_cvt_pk_bf16_f32 v2, 0, v2
    v_cvt_pk_bf16_f32 v3, 0, v3
    v_cvt_pk_bf16_f32 v4, 0, v4
    v_mul_f32 v2, 0x3db504f3, v2
    v_mul_f32 v3, 0x3db504f3, v3
    v_mul_f32 v4, 0x3db504f3, v4
    v_cvt_pk_bf16_f32 v2, 0, v2
    v_cvt_pk_bf16_f32 v3, 0, v3
    v_cvt_pk_bf16_f32 v4, 0, v4
    v_mov_b32 v7, 0xff800000
    s_sub_i32 s9, s8, 0
    v_cmp_le_i32 vcc, s9, v9
    s_nop 1
    v_cndmask_b32 v2, v7, v2, vcc
    s_sub_i32 s9, s8, 4
    v_cmp_le_i32 vcc, s9, v9
    s_nop 1
    v_cndmask_b32 v3, v7, v3, vcc
    s_sub_i32 s9, s8, 8
    v_cmp_le_i32 vcc, s9, v9
    s_nop 0
    s_and_b32 vcc_lo, vcc_lo, 0xff00ff
    s_and_b32 vcc_hi, vcc_hi, 0xff00ff
    v_cndmask_b32 v4, v7, v4, vcc
    v_max3_f32 v124, v2, v3, v4
    v_max_f32 v124, 0xff7fffff, v124
    s_nop 1
    v_max_f32_dpp v124, v124, v124 row_ror:4 row_mask:0xf bank_mask:0xf
    s_nop 1
    v_max_f32_dpp v124, v124, v124 row_ror:8 row_mask:0xf bank_mask:0xf
    v_mov_b32 v5, v124
    s_nop 1
    v_permlane16_swap_b32 v124, v5
    v_max_f32 v124, v124, v5
    v_mov_b32 v5, v124
    s_nop 1
    v_permlane32_swap_b32 v124, v5
    v_max_f32 v124, v124, v5
    v_sub_f32 v2, v2, v124
    v_sub_f32 v3, v3, v124
    v_sub_f32 v4, v4, v124
    v_mul_f32 v2, 0x3fb8aa3b, v2
    v_mul_f32 v3, 0x3fb8aa3b, v3
    v_mul_f32 v4, 0x3fb8aa3b, v4
    v_exp_f32 v2, v2
    v_exp_f32 v3, v3
    v_exp_f32 v4, v4
    v_add_f32 v125, v2, v3
    v_cvt_pk_bf16_f32 v5, v2, v2
    v_cvt_pk_bf16_f32 v6, v3, v3
    v_cvt_pk_bf16_f32 v7, v4, v4
    v_add_f32 v125, v125, v4
    s_nop 1
    v_add_f32_dpp v125, v125, v125 row_ror:4 row_mask:0xf bank_mask:0xf
    s_nop 1
    v_add_f32_dpp v125, v125, v125 row_ror:8 row_mask:0xf bank_mask:0xf
    v_mov_b32 v1, v125
    s_nop 1
    v_permlane16_swap_b32 v125, v1
    v_add_f32 v125, v125, v1
    v_mov_b32 v1, v125
    s_nop 1
    v_permlane32_swap_b32 v125, v1
    v_add_f32 v125, v125, v1
    s_mul_i32 s9, s3, 576
    s_add_u32 s9, s9, 98304
    v_and_b32 v2, 15, v0
    v_lshlrev_b32 v2, 5, v2
    v_and_b32 v3, 16, v0
    v_add3_u32 v2, v2, v3, s9
    s_lshl_b32 s9, s3, 3
    s_add_u32 s9, s9, 107520
    v_mov_b32 v3, s9
    ds_write_b64 v3, v[124:125]
    s_mov_b64 exec, 1
    v_mov_b32 v1, 1
    ds_add_u32 v15, v1 offset:40
    s_mov_b64 exec, -1
    v_and_b32_dpp v16, v5, v112 row_newbcast:0 row_mask:0xf bank_mask:0xf
    v_and_b32_dpp v17, v5, v113 row_newbcast:0 row_mask:0xf bank_mask:0xf
    v_and_b32_dpp v18, v5, v114 row_newbcast:0 row_mask:0xf bank_mask:0xf
    v_and_b32_dpp v19, v5, v115 row_newbcast:0 row_mask:0xf bank_mask:0xf
    v_and_b32_dpp v20, v5, v112 row_newbcast:4 row_mask:0xf bank_mask:0xf
    v_and_b32_dpp v21, v5, v113 row_newbcast:4 row_mask:0xf bank_mask:0xf
    v_and_b32_dpp v22, v5, v114 row_newbcast:4 row_mask:0xf bank_mask:0xf
    v_and_b32_dpp v23, v5, v115 row_newbcast:4 row_mask:0xf bank_mask:0xf
    v_and_b32_dpp v24, v5, v112 row_newbcast:8 row_mask:0xf bank_mask:0xf
    v_and_b32_dpp v25, v5, v113 row_newbcast:8 row_mask:0xf bank_mask:0xf
    v_and_b32_dpp v26, v5, v114 row_newbcast:8 row_mask:0xf bank_mask:0xf
    v_and_b32_dpp v27, v5, v115 row_newbcast:8 row_mask:0xf bank_mask:0xf
    v_and_b32_dpp v28, v5, v112 row_newbcast:12 row_mask:0xf bank_mask:0xf
    v_and_b32_dpp v29, v5, v113 row_newbcast:12 row_mask:0xf bank_mask:0xf
    v_and_b32_dpp v30, v5, v114 row_newbcast:12 row_mask:0xf bank_mask:0xf
    v_and_b32_dpp v31, v5, v115 row_newbcast:12 row_mask:0xf bank_mask:0xf
    v_and_b32_dpp v32, v6, v112 row_newbcast:0 row_mask:0xf bank_mask:0xf
    v_and_b32_dpp v33, v6, v113 row_newbcast:0 row_mask:0xf bank_mask:0xf
Lpad_M_2:
    s_cbranch_execz Lpad_M_6
    v_and_b32_dpp v34, v6, v114 row_newbcast:0 row_mask:0xf bank_mask:0xf
    v_and_b32_dpp v35, v6, v115 row_newbcast:0 row_mask:0xf bank_mask:0xf
    v_and_b32_dpp v36, v6, v112 row_newbcast:4 row_mask:0xf bank_mask:0xf
    v_and_b32_dpp v37, v6, v113 row_newbcast:4 row_mask:0xf bank_mask:0xf
    v_and_b32_dpp v38, v6, v114 row_newbcast:4 row_mask:0xf bank_mask:0xf
    v_and_b32_dpp v39, v6, v115 row_newbcast:4 row_mask:0xf bank_mask:0xf
    v_and_b32_dpp v40, v6, v112 row_newbcast:8 row_mask:0xf bank_mask:0xf
    v_and_b32_dpp v41, v6, v113 row_newbcast:8 row_mask:0xf bank_mask:0xf
    v_and_b32_dpp v42, v6, v114 row_newbcast:8 row_mask:0xf bank_mask:0xf
    v_and_b32_dpp v43, v6, v115 row_newbcast:8 row_mask:0xf bank_mask:0xf
    v_and_b32_dpp v44, v6, v112 row_newbcast:12 row_mask:0xf bank_mask:0xf
    v_and_b32_dpp v45, v6, v113 row_newbcast:12 row_mask:0xf bank_mask:0xf
    v_and_b32_dpp v46, v6, v114 row_newbcast:12 row_mask:0xf bank_mask:0xf
    v_and_b32_dpp v47, v6, v115 row_newbcast:12 row_mask:0xf bank_mask:0xf
    v_and_b32_dpp v48, v7, v112 row_newbcast:0 row_mask:0xf bank_mask:0xf
    v_and_b32_dpp v49, v7, v113 row_newbcast:0 row_mask:0xf bank_mask:0xf
    v_and_b32_dpp v50, v7, v114 row_newbcast:0 row_mask:0xf bank_mask:0xf
    v_and_b32_dpp v51, v7, v115 row_newbcast:0 row_mask:0xf bank_mask:0xf
    v_and_b32_dpp v52, v7, v112 row_newbcast:4 row_mask:0xf bank_mask:0xf
    v_and_b32_dpp v53, v7, v113 row_newbcast:4 row_mask:0xf bank_mask:0xf
    v_and_b32_dpp v54, v7, v114 row_newbcast:4 row_mask:0xf bank_mask:0xf
    v_and_b32_dpp v55, v7, v115 row_newbcast:4 row_mask:0xf bank_mask:0xf
    v_lshrrev_b32 v96, 2, v0
    v_lshlrev_b32 v97, 3, v96
    v_add_u32 v97, 107520, v97
    v_mul_u32_u24 v96, 576, v96
    v_and_b32 v99, 3, v0
    v_lshl_add_u32 v96, v99, 4, v96
    s_and_b32 s10, s3, 7
    s_lshl_b32 s10, s10, 6
    s_add_u32 s9, s10, 98304
    v_add_u32 v96, s9, v96
    v_bfe_u32 v98, v0, 4, 1
    v_bfe_u32 v1, v0, 5, 1
    v_lshl_add_u32 v98, v98, 1, v1
    v_lshl_add_u32 v98, v99, 2, v98
    s_lshl_b32 s11, s4, 9
    s_add_u32 s11, s11, 65536
    s_add_u32 s10, s10, s11
    v_lshl_add_u32 v98, v98, 2, s10
    s_lshl_b32 s11, s4, 3
    s_add_u32 s11, s11, 196608
    v_mov_b32 v99, s11
    s_cmp_eq_u32 s58, 0
    s_cbranch_scc1 LVissued
    s_cmp_eq_u32 s8, 1
    s_cbranch_scc1 Lld49_1
    s_cmp_lg_u32 s8, 0
    s_cbranch_scc1 Lskip49
Lld49_0:
    buffer_load_dwordx4 v[56:59], v11, s[48:51], 0 offen offset:0 nt
Lld49_1:
    buffer_load_dwordx4 v[60:63], v11, s[48:51], s60 offen offset:0 nt
Lld49_2:
    buffer_load_dwordx4 v[64:67], v11, s[48:51], s61 offen offset:0 nt
Lld49_3:
    buffer_load_dwordx4 v[68:71], v11, s[48:51], s83 offen offset:0 nt
Lld49_4:
    buffer_load_dwordx4 v[72:75], v11, s[48:51], s84 offen offset:0 nt
Lld49_5:
    buffer_load_dwordx4 v[76:79], v11, s[48:51], s85 offen offset:0 nt
Lld49_6:
    buffer_load_dwordx4 v[80:83], v11, s[48:51], s86 offen offset:0 nt
Lld49_7:
    buffer_load_dwordx4 v[84:87], v11, s[48:51], s87 offen offset:0 nt
Lld49_8:
    buffer_load_dwordx4 v[88:91], v11, s[48:51], s88 offen offset:0 nt
Lld49_9:
    buffer_load_dwordx4 v[92:95], v11, s[48:51], s89 offen offset:0 nt
Lld49_10:
    s_mov_b64 exec, 1
    v_mov_b32 v1, 1
    ds_add_u32 v15, v1 offset:4
    s_mov_b64 exec, -1
LVissued:
    s_cmp_lt_u32 s3, 8
    s_cbranch_scc1 Lnofac
    s_mov_b32 s15, 0
Lw_2:
    ds_read_b32 v1, v15 offset:40
    s_waitcnt lgkmcnt(0)
    v_readfirstlane_b32 s9, v1
    s_nop 0
    s_cmp_ge_u32 s9, 16
    s_cbranch_scc1 Lw_2_ok
    s_add_u32 s15, s15, 1
    s_cmp_lt_u32 s15, 524288
    s_sleep 1
    s_cbranch_scc1 Lw_2
Lw_2_ok:
    ds_read_b64 v[100:101], v97
    s_waitcnt lgkmcnt(0)
    v_max_f32_dpp v102, v100, v100 row_ror:4 row_mask:0xf bank_mask:0xf
    s_nop 1
    v_max_f32_dpp v102, v102, v102 row_ror:8 row_mask:0xf bank_mask:0xf
    v_mov_b32 v1, v102
    s_nop 1
    v_permlane16_swap_b32 v102, v1
    v_max_f32 v102, v102, v1
    v_mov_b32 v1, v102
    s_nop 1
    v_permlane32_swap_b32 v102, v1
    v_max_f32 v102, v102, v1
    v_sub_f32 v100, v100, v102
    v_mul_f32 v100, 0x3fb8aa3b, v100
    v_exp_f32 v100, v100
    s_nop 0
    v_mul_f32 v103, v101, v100
    s_nop 1
    v_add_f32_dpp v103, v103, v103 row_ror:4 row_mask:0xf bank_mask:0xf
    s_nop 1
    v_add_f32_dpp v103, v103, v103 row_ror:8 row_mask:0xf bank_mask:0xf
    v_mov_b32 v1, v103
    s_nop 1
    v_permlane16_swap_b32 v103, v1
    v_add_f32 v103, v103, v1
    v_mov_b32 v1, v103
    s_nop 1
    v_permlane32_swap_b32 v103, v1
    v_add_f32 v103, v103, v1
    v_mov_b32 v101, v100
Lnofac:
    s_waitcnt vmcnt(9)
    v_mfma_f32_16x16x32_bf16 v[116:119], v[16:19], v[56:59], 0
    s_waitcnt vmcnt(8)
    v_mfma_f32_16x16x32_bf16 v[116:119], v[20:23], v[60:63], v[116:119]
    s_waitcnt vmcnt(7)
    v_mfma_f32_16x16x32_bf16 v[116:119], v[24:27], v[64:67], v[116:119]
    s_waitcnt vmcnt(6)
    v_mfma_f32_16x16x32_bf16 v[116:119], v[28:31], v[68:71], v[116:119]
    s_waitcnt vmcnt(5)
    v_mfma_f32_16x16x32_bf16 v[116:119], v[32:35], v[72:75], v[116:119]
    s_waitcnt vmcnt(4)
    v_mfma_f32_16x16x32_bf16 v[116:119], v[36:39], v[76:79], v[116:119]
    s_waitcnt vmcnt(3)
    v_mfma_f32_16x16x32_bf16 v[116:119], v[40:43], v[80:83], v[116:119]
    s_waitcnt vmcnt(2)
    v_mfma_f32_16x16x32_bf16 v[116:119], v[44:47], v[84:87], v[116:119]
    s_waitcnt vmcnt(1)
    v_mfma_f32_16x16x32_bf16 v[116:119], v[48:51], v[88:91], v[116:119]
    s_waitcnt vmcnt(0)
    v_mfma_f32_16x16x32_bf16 v[116:119], v[52:55], v[92:95], v[116:119]
    s_mov_b32 exec_hi, 0
    v_mov_b32 v1, 1
    s_nop 5
    ds_write_b128 v2, v[116:119]
    s_mov_b64 exec, 1
    ds_add_u32 v15, v1 offset:8
    s_mov_b64 exec, -1
    s_cmp_lt_u32 s3, 8
    s_cbranch_scc1 Ltail
    s_setprio 3
    s_mov_b32 s15, 0
Lcw:
    ds_read_b64 v[32:33], v15 offset:8
    ds_read_b128 v[20:23], v96
    s_waitcnt lgkmcnt(1)
    v_readfirstlane_b32 s9, v32
    v_readfirstlane_b32 s14, v33
    s_nop 0
    s_lshl_b32 s10, s14, 3
    s_and_b32 s9, s9, s10
    s_cmp_ge_u32 s9, 16
    s_cbranch_scc1 Lcw_ok
    s_add_u32 s15, s15, 1
    s_cmp_lt_u32 s15, 524288
    s_cbranch_scc1 Lcw
Lcw_ok:
    s_waitcnt lgkmcnt(0)
    v_pk_mul_f32 v[20:21], v[20:21], v[100:101]
    v_pk_mul_f32 v[22:23], v[22:23], v[100:101]
    s_nop 0
    v_permlane32_swap_b32 v20, v21
    v_permlane32_swap_b32 v22, v23
    v_add_f32 v20, v20, v21
    v_add_f32 v22, v22, v23
    s_nop 1
    v_permlane16_swap_b32 v20, v22
    v_add_f32 v20, v20, v22
    s_nop 1
    v_add_f32_dpp v20, v20, v20 row_ror:4 row_mask:0xf bank_mask:0xf
    s_nop 1
    v_add_f32_dpp v20, v20, v20 row_ror:8 row_mask:0xf bank_mask:0xf
    s_mov_b32 exec_lo, 0x000f000f
    s_mov_b32 exec_hi, 0x000f000f
    s_bitcmp1_b32 s14, 0
    s_cbranch_scc0 Lcombfar
    global_store_dword v98, v20, s[42:43]
    s_cmp_eq_u32 s3, 8
    s_cbranch_scc0 Lcombdone
    s_mov_b64 exec, 1
    global_store_dwordx2 v99, v[102:103], s[42:43]
    s_branch Lcombdone
Lcombfar:
    global_store_dword v98, v20, s[42:43] sc1
    s_cmp_eq_u32 s3, 8
Lpad_M_3:
    s_cbranch_execz Lpad_M_7
    s_cbranch_scc0 Lcombdone
    s_mov_b64 exec, 1
    global_store_dwordx2 v99, v[102:103], s[42:43] sc1
Lcombdone:
    s_mov_b64 exec, 1
    v_mov_b32 v1, 1
    ds_add_u32 v15, v1 offset:16
    s_mov_b64 exec, -1
    s_endpgm
Ltail:
    s_sub_u32 s9, s3, 1
    s_cmp_lt_u32 s9, 3
    s_cbranch_scc0 Lnoprobe
    s_lshl_b32 s10, s4, 2
    s_add_u32 s10, s10, s3
    s_lshl_b32 s10, s10, 7
    s_andn2_b32 s10, s10, 0x2000
    s_add_u32 s10, s10, 65536
    s_mov_b32 s11, 0
    s_mov_b64 exec, 1
Lprobe:
    s_memtime s[64:65]
    s_waitcnt lgkmcnt(0)
    s_load_dword s12, s[42:43], s10 glc
    s_waitcnt lgkmcnt(0)
    s_memtime s[66:67]
    ds_read_b32 v1, v15 offset:4
    s_and_b32 s13, s11, 1
    s_lshl_b32 s13, s13, 2
    v_add_u32 v3, s13, v15
    s_waitcnt lgkmcnt(0)
    s_sub_u32 s12, s64, s66
    v_mov_b32 v2, s12
    ds_max_u32 v3, v2 offset:48
    v_readfirstlane_b32 s9, v1
    s_xor_b32 s10, s10, 0x2000
    s_add_u32 s11, s11, 1
    s_cmp_ge_u32 s9, 14
    s_cselect_b32 s9, 2, 2
    s_cmp_lt_u32 s11, s9
    s_cbranch_scc1 Lprobe
    s_mov_b64 exec, -1
Lnoprobe:
    s_cmp_eq_u32 s3, 6
    s_cbranch_scc0 Lnoestat
    s_mov_b32 s15, 0
Lw_3:
    ds_read_b32 v1, v15 offset:12
    s_waitcnt lgkmcnt(0)
    v_readfirstlane_b32 s9, v1
    s_nop 0
    s_cmp_ge_u32 s9, 2
    s_cbranch_scc1 Lw_3_ok
    s_add_u32 s15, s15, 1
    s_cmp_lt_u32 s15, 524288
    s_sleep 1
    s_cbranch_scc1 Lw_3
Lw_3_ok:
    s_mov_b32 s14, s9
    s_mov_b32 s15, 0
Lw_4:
    ds_read_b32 v1, v15 offset:40
    s_waitcnt lgkmcnt(0)
    v_readfirstlane_b32 s9, v1
    s_nop 0
    s_cmp_ge_u32 s9, 16
    s_cbranch_scc1 Lw_4_ok
    s_add_u32 s15, s15, 1
    s_cmp_lt_u32 s15, 524288
    s_sleep 1
    s_cbranch_scc1 Lw_4
Lw_4_ok:
    ds_read_b64 v[100:101], v97
    s_waitcnt lgkmcnt(0)
    v_max_f32_dpp v102, v100, v100 row_ror:4 row_mask:0xf bank_mask:0xf
    s_nop 1
    v_max_f32_dpp v102, v102, v102 row_ror:8 row_mask:0xf bank_mask:0xf
    v_mov_b32 v1, v102
    s_nop 1
    v_permlane16_swap_b32 v102, v1
    v_max_f32 v102, v102, v1
    v_mov_b32 v1, v102
    s_nop 1
    v_permlane32_swap_b32 v102, v1
    v_max_f32 v102, v102, v1
    v_sub_f32 v100, v100, v102
    v_mul_f32 v100, 0x3fb8aa3b, v100
    v_exp_f32 v100, v100
    s_nop 0
    v_mul_f32 v103, v101, v100
    s_nop 1
    v_add_f32_dpp v103, v103, v103 row_ror:4 row_mask:0xf bank_mask:0xf
    s_nop 1
    v_add_f32_dpp v103, v103, v103 row_ror:8 row_mask:0xf bank_mask:0xf
    v_mov_b32 v1, v103
    s_nop 1
    v_permlane16_swap_b32 v103, v1
    v_add_f32 v103, v103, v1
    v_mov_b32 v1, v103
    s_nop 1
    v_permlane32_swap_b32 v103, v1
    v_add_f32 v103, v103, v1
    s_mov_b64 exec, 1
    s_bitcmp1_b32 s14, 0
    s_cbranch_scc0 Lestatfar
    global_store_dwordx2 v99, v[102:103], s[42:43] offset:2048
    s_branch Lestatdone
Lestatfar:
    global_store_dwordx2 v99, v[102:103], s[42:43] offset:2048 sc1
Lestatdone:
    s_mov_b64 exec, -1
Lnoestat:
    s_and_b32 s13, s4, 8
    s_lshl_b32 s13, s13, 1
    s_lshr_b32 s9, s4, 5
    s_add_u32 s13, s13, s9
    s_lshl_b32 s9, s5, 3
    s_add_u32 s13, s13, s9
    s_and_b32 s9, s4, 0x16
    s_cmp_eq_u32 s9, 0x12
    s_cbranch_scc1 LroleM
    s_cmp_eq_u32 s3, 0
    s_cbranch_scc0 Lnoticket
    s_mov_b32 s15, 0
Lw_5:
    ds_read_b32 v1, v15 offset:12
    s_waitcnt lgkmcnt(0)
    v_readfirstlane_b32 s9, v1
    s_nop 0
    s_cmp_ge_u32 s9, 2
    s_cbranch_scc1 Lw_5_ok
    s_add_u32 s15, s15, 1
    s_cmp_lt_u32 s15, 524288
    s_sleep 1
    s_cbranch_scc1 Lw_5
Lw_5_ok:
    s_mov_b32 s15, 0
Lw_6:
    ds_read_b32 v1, v15 offset:4
    s_waitcnt lgkmcnt(0)
    v_readfirstlane_b32 s9, v1
    s_nop 0
    s_cmp_ge_u32 s9, 16
    s_cbranch_scc1 Lw_6_ok
    s_add_u32 s15, s15, 1
    s_cmp_lt_u32 s15, 524288
    s_sleep 1
    s_cbranch_scc1 Lw_6
Lw_6_ok:
    s_and_b32 s11, s4, 0xe0
    s_lshl_b32 s11, s11, 3
    s_add_u32 s11, s11, 202752
    ds_read_b64 v[2:3], v15 offset:48
    s_waitcnt lgkmcnt(0)
    v_cmp_gt_u32 vcc, v3, v2
    s_nop 0
    s_and_b32 s10, vcc_lo, 0x2000
    s_lshr_b32 s10, s10, 5
    s_add_u32 s10, s10, 1
    s_mov_b32 s12, s10
    s_atomic_add s12, s[42:43], s11 glc
    s_waitcnt lgkmcnt(0)
    s_add_u32 s12, s12, 1
    s_add_u32 s12, s12, s10
    s_mov_b64 exec, 1
    v_mov_b32 v1, s12
    ds_add_u32 v15, v1 offset:32
    s_mov_b64 exec, -1
Lnoticket:
    s_mov_b32 s15, 0
Lw_7:
    ds_read_b32 v1, v15 offset:32
    s_waitcnt lgkmcnt(0)
    v_readfirstlane_b32 s9, v1
    s_nop 0
    s_cmp_ge_u32 s9, 1
    s_cbranch_scc1 Lw_7_ok
    s_add_u32 s15, s15, 1
    s_cmp_lt_u32 s15, 524288
    s_sleep 1
    s_cbranch_scc1 Lw_7
Lw_7_ok:
    s_lshr_b32 s63, s9, 7
    s_and_b32 s9, s9, 0xff
    s_cmp_gt_u32 s63, s9
    s_cselect_b32 s63, 0x2000, 0
    s_sub_u32 s6, s9, 1
    s_lshr_b32 s10, s4, 5
    s_min_u32 s11, s10, 3
    s_mul_i32 s12, s10, 5
    s_add_u32 s11, s11, s12
    s_cmp_lt_u32 s10, 3
    s_cselect_b32 s12, 6, 5
    s_sub_u32 s9, s6, 16
    s_cmp_lt_u32 s9, 11
    s_cbranch_scc0 Lnoown
    s_lshl_b32 s9, s9, 3
    s_add_u32 s9, s9, s3
    s_mul_i32 s9, s9, 6
    v_lshrrev_b32 v2, 2, v0
    v_add_u32 v2, s9, v2
    v_min_u32 v2, 511, v2
    v_and_b32 v3, 3, v0
    v_lshlrev_b32 v3, 7, v3
    s_lshl_b32 s9, s12, 6
    s_sub_u32 s9, s9, 4
    v_min_u32 v3, s9, v3
    s_lshl_b32 s9, s11, 6
    v_add_u32 v3, s9, v3
    v_mul_u32_u24 v2, 2752, v2
    v_add_u32 v2, v2, v3
    s_cmp_ge_u32 s3, 4
    s_cselect_b32 s62, 8, 0
    s_mov_b32 s15, 0
Lw_8:
    ds_read_b32 v1, v15 offset:16
    s_waitcnt lgkmcnt(0)
    v_readfirstlane_b32 s9, v1
    s_nop 0
    s_cmp_ge_u32 s9, s62
    s_cbranch_scc1 Lw_8_ok
    s_add_u32 s15, s15, 1
    s_cmp_lt_u32 s15, 524288
    s_sleep 1
    s_cbranch_scc1 Lw_8
Lw_8_ok:
    s_mov_b32 exec_lo, 0xffffff
    s_mov_b32 exec_hi, 0x0
    global_load_dword v126, v2, s[28:29]
    global_load_dword v126, v2, s[30:31]
    s_mov_b64 exec, -1
Lnoown:
    s_sub_u32 s9, s6, 16
Lpad_M_4:
    s_cbranch_execz Lpad_M_8
    s_add_u32 s13, s11, s9
    s_cmp_lt_u32 s9, s12
    s_cbranch_scc1 LroleU
    s_cmp_lt_u32 s6, 16
    s_cbranch_scc0 LWend
    s_lshl_b32 s13, s10, 1
    s_add_u32 s13, s13, s9
    s_and_b32 s13, s13, 15
    s_lshl_b32 s9, s13, 1
    s_and_b32 s62, s3, 1
    s_add_u32 s9, s9, s62
    s_mul_i32 s9, s9, s12
    s_lshl_b32 s62, s11, 5
    s_add_u32 s9, s9, s62
    s_lshl_b32 s9, s9, 10
    s_lshl_b32 s62, s12, 3
    s_sub_u32 s62, s62, 1
    v_min_u32 v7, s62, v0
    v_lshl_add_u32 v7, v7, 7, s9
    s_mov_b32 s52, s24
    s_mov_b32 s53, s25
    s_mov_b32 s54, 4194304
    s_mov_b32 s55, 0x20000
    v_lshrrev_b32 v1, 2, v0
    v_and_b32 v9, 8, v1
    v_xor_b32 v9, v9, v0
    v_bfe_u32 v8, v9, 2, 1
    v_bfe_u32 v1, v9, 3, 1
    v_lshl_add_u32 v8, v8, 1, v1
    v_lshrrev_b32 v1, 4, v0
    v_lshl_add_u32 v8, v1, 2, v8
    v_mul_u32_u24 v8, 1024, v8
    v_lshlrev_b32 v1, 1, v1
    v_xor_b32 v1, v1, v0
    v_and_b32 v1, 3, v1
    v_lshl_add_u32 v8, v1, 4, v8
    s_lshl_b32 s12, s3, 12
    s_add_u32 s12, s12, 65536
    s_lshl_b32 s14, s10, 3
    s_add_u32 s14, s14, s3
    s_lshl_b32 s11, s14, 16
    s_lshl_b32 s9, s13, 6
    s_add_u32 s11, s11, s9
    s_and_b32 s9, s13, 1
    s_lshl_b32 s70, s9, 15
    s_add_u32 s70, s70, s11
    s_xor_b32 s71, s70, 0x8000
    s_lshl_b32 s72, s9, 11
    s_add_u32 s72, s72, s12
    s_xor_b32 s73, s72, 0x800
    v_lshrrev_b32 v5, 4, v0
    v_add_u32 v5, v5, v0
    v_and_b32 v5, 7, v5
    s_lshr_b32 s9, s14, 1
    s_lshl_b32 s9, s9, 6
    s_add_u32 s9, s9, 196608
    v_lshl_add_u32 v5, v5, 3, s9
    global_load_dwordx2 v[56:57], v5, s[42:43] offset:2048 sc1
    s_add_u32 m0, s72, 0
    s_nop 0
    buffer_load_dwordx4 v8, s[52:55], s70 offen  lds
    s_add_u32 s70, s70, 16384
    s_add_u32 m0, s72, 1024
    s_nop 0
    buffer_load_dwordx4 v8, s[52:55], s70 offen  lds
    s_add_u32 s70, s70, 16384
    s_lshr_b32 s9, s3, 2
    s_lshl_b32 s9, s9, 10
    s_and_b32 s62, s3, 3
    s_lshl_b32 s62, s62, 2
    s_add_u32 s9, s9, s62
    v_add_u32 v14, 108032, v11
    v_add_u32 v13, s9, v14
    s_mov_b32 s66, 0xffff0000
    s_mov_b32 s67, 0xffff0000
    s_mov_b32 s68, 0
    s_mov_b32 s69, -1
    v_lshrrev_b32 v5, 4, v0
    v_lshlrev_b32 v6, 9, v5
    v_and_b32 v1, 15, v0
    v_lshl_add_u32 v6, v1, 4, v6
    s_and_b32 s9, s3, 1
    s_lshl_b32 s9, s9, 8
    s_add_u32 s9, s9, 65536
    s_lshr_b32 s14, s14, 1
    s_lshl_b32 s62, s14, 12
    s_add_u32 s9, s9, s62
    v_add_u32 v6, s9, v6
    v_add_u32 v5, v5, v0
    v_and_b32 v5, 7, v5
    s_lshl_b32 s9, s14, 6
    s_add_u32 s9, s9, 196608
    v_lshl_add_u32 v5, v5, 3, s9
    s_lshr_b32 s9, s13, 3
    s_lshl_b32 s9, s9, 14
    s_bfe_u32 s62, s13, 0x20001
    s_lshl_b32 s62, s62, 11
    s_add_u32 s9, s9, s62
    s_lshl_b32 s62, s10, 8
    s_add_u32 s9, s9, s62
    s_and_b32 s62, s13, 1
    s_lshl_b32 s62, s62, 7
    s_add_u32 s9, s9, s62
    s_add_u32 s9, s9, 212992
    v_and_b32 v4, 31, v0
    v_lshl_add_u32 v4, v4, 2, s9
    v_lshrrev_b32 v1, 5, v0
    v_lshl_add_u32 v4, v1, 13, v4
    s_lshl_b32 s9, s10, 4
    s_add_u32 s13, s13, s9
    v_bfe_u32 v101, v0, 2, 2
    v_and_b32 v1, 2, v101
    v_lshrrev_b32 v100, 4, v0
    v_xor_b32 v100, v100, v1
    v_lshl_add_u32 v100, v101, 2, v100
    v_lshlrev_b32 v100, 6, v100
    v_and_b32 v1, 1, v101
    v_lshl_add_u32 v100, v1, 5, v100
    v_and_b32 v1, 3, v0
    v_lshl_add_u32 v100, v1, 3, v100
    v_add_u32 v100, s12, v100
    v_xor_b32 v101, 32, v100
    s_mov_b32 s15, 0
Lw_9:
    ds_read_b32 v1, v15 offset:16
    s_waitcnt lgkmcnt(0)
    v_readfirstlane_b32 s9, v1
    s_nop 0
    s_cmp_ge_u32 s9, 8
    s_cbranch_scc1 Lw_9_ok
    s_add_u32 s15, s15, 1
    s_cmp_lt_u32 s15, 524288
    s_sleep 1
    s_cbranch_scc1 Lw_9
Lw_9_ok:
    s_setprio 1
    s_add_u32 m0, s73, 0
    s_nop 0
    buffer_load_dwordx4 v8, s[52:55], s71 offen  lds
    s_add_u32 s71, s71, 16384
    s_add_u32 m0, s73, 1024
    s_nop 0
    buffer_load_dwordx4 v8, s[52:55], s71 offen  lds
    s_add_u32 s71, s71, 16384
    s_setprio 0
    s_mov_b64 exec, 1
    v_mov_b32 v1, 1
    ds_add_u32 v15, v1 offset:20
    s_mov_b64 exec, -1
    global_load_dwordx4 v[48:51], v6, s[42:43] sc1
    global_load_dwordx4 v[52:55], v6, s[42:43] offset:2048 sc1
    s_waitcnt vmcnt(6)
    v_max_u32 v2, v56, v57
    v_cmp_eq_u32 vcc, -1, v2
    s_nop 0
    s_cbranch_vccz LWstat
    s_mov_b32 s15, 0
Lpoll_10:
    global_load_dwordx2 v[56:57], v5, s[42:43] offset:2048 sc1
    s_waitcnt vmcnt(0)
    v_max_u32 v2, v56, v57
    v_cmp_eq_u32 vcc, -1, v2
    s_nop 0
    s_and_b64 exec, exec, vcc
    s_cbranch_scc0 Lpoll_10_ok
    s_add_u32 s15, s15, 1
    s_cmp_lt_u32 s15, 131072
    s_cbranch_scc1 Lpoll_10
Lpoll_10_ok:
    s_mov_b64 exec, -1
    global_load_dwordx4 v[48:51], v6, s[42:43] sc1
    global_load_dwordx4 v[52:55], v6, s[42:43] offset:2048 sc1
LWstat:
    v_max_f32_dpp v2, v56, v56 quad_perm:[1,0,3,2] row_mask:0xf bank_mask:0xf
    s_nop 1
    v_max_f32_dpp v2, v2, v2 quad_perm:[2,3,0,1] row_mask:0xf bank_mask:0xf
    s_nop 1
    v_max_f32_dpp v2, v2, v2 row_half_mirror row_mask:0xf bank_mask:0xf
    v_sub_f32 v2, v56, v2
    v_mul_f32 v2, 0x3fb8aa3b, v2
    v_exp_f32 v2, v2
    s_nop 0
    v_mul_f32 v3, v57, v2
    s_nop 1
    v_add_f32_dpp v3, v3, v3 quad_perm:[1,0,3,2] row_mask:0xf bank_mask:0xf
    s_nop 1
    v_add_f32_dpp v3, v3, v3 quad_perm:[2,3,0,1] row_mask:0xf bank_mask:0xf
    s_nop 1
    v_add_f32_dpp v3, v3, v3 row_half_mirror row_mask:0xf bank_mask:0xf
    v_rcp_f32 v3, v3
    s_nop 0
    v_mul_f32 v2, v2, v3
    s_waitcnt vmcnt(2)
    ds_read_b64_tr_b16 v[16:17], v100 offset:0
    ds_read_b64_tr_b16 v[18:19], v100 offset:1024
    ds_read_b64_tr_b16 v[20:21], v101 offset:0
    ds_read_b64_tr_b16 v[22:23], v101 offset:1024
    ds_read_b64_tr_b16 v[24:25], v100 offset:2048
    ds_read_b64_tr_b16 v[26:27], v100 offset:3072
Lpad_M_5:
    s_cbranch_execz Lpad_M_9
    ds_read_b64_tr_b16 v[28:29], v101 offset:2048
    ds_read_b64_tr_b16 v[30:31], v101 offset:3072
    s_mov_b32 s15, 0
Lfast_11:
    s_waitcnt vmcnt(0)
Lfast_11_in:
    v_mul_f32_dpp v64, v2, v48 row_newbcast:0 row_mask:0xf bank_mask:0xf
    v_mul_f32_dpp v65, v2, v49 row_newbcast:0 row_mask:0xf bank_mask:0xf
    v_mul_f32_dpp v66, v2, v50 row_newbcast:0 row_mask:0xf bank_mask:0xf
    v_mul_f32_dpp v67, v2, v51 row_newbcast:0 row_mask:0xf bank_mask:0xf
    v_fmac_f32_dpp v64, v2, v52 row_newbcast:4 row_mask:0xf bank_mask:0xf
    v_fmac_f32_dpp v65, v2, v53 row_newbcast:4 row_mask:0xf bank_mask:0xf
    v_fmac_f32_dpp v66, v2, v54 row_newbcast:4 row_mask:0xf bank_mask:0xf
    v_fmac_f32_dpp v67, v2, v55 row_newbcast:4 row_mask:0xf bank_mask:0xf
    v_permlane32_swap_b32 v64, v65
    s_nop 0
    v_permlane32_swap_b32 v66, v67
    v_add_f32 v64, v64, v65
    v_add_f32 v66, v66, v67
    s_nop 1
    v_permlane16_swap_b32 v64, v66
    v_add_f32 v64, v64, v66
    v_cmp_u_f32 vcc, v64, v64
    s_nop 0
    s_cbranch_vccz Lfast_11_ok
    v_max3_u32 v3, v48, v49, v50
    v_max3_u32 v3, v3, v51, v52
    v_max3_u32 v3, v3, v53, v54
    v_max_u32 v3, v3, v55
    v_cmp_eq_u32 vcc, -1, v3
    s_nop 0
    s_cbranch_vccz Lfast_11_ok
    s_mov_b64 exec, vcc
    global_load_dwordx4 v[48:51], v6, s[42:43] sc1
    global_load_dwordx4 v[52:55], v6, s[42:43] offset:2048 sc1
    s_mov_b64 exec, -1
    s_add_u32 s15, s15, 1
    s_cmp_lt_u32 s15, 131072
    s_cbranch_scc1 Lfast_11
    s_waitcnt vmcnt(0)
Lfast_11_ok:
    v_mov_b32_dpp v73, v64 row_shl:1 row_mask:0xf bank_mask:0xf
    v_cvt_pk_bf16_f32 v64, v64, v73
    s_nop 1
    v_mov_b32_dpp v72, v64 row_newbcast:0 row_mask:0xf bank_mask:0xf
    v_mov_b32_dpp v73, v64 row_newbcast:2 row_mask:0xf bank_mask:0xf
    v_mov_b32_dpp v74, v64 row_newbcast:4 row_mask:0xf bank_mask:0xf
    v_mov_b32_dpp v75, v64 row_newbcast:6 row_mask:0xf bank_mask:0xf
    v_mov_b32_dpp v76, v64 row_newbcast:8 row_mask:0xf bank_mask:0xf
    v_mov_b32_dpp v77, v64 row_newbcast:10 row_mask:0xf bank_mask:0xf
    v_mov_b32_dpp v78, v64 row_newbcast:12 row_mask:0xf bank_mask:0xf
    v_mov_b32_dpp v79, v64 row_newbcast:14 row_mask:0xf bank_mask:0xf
    s_waitcnt lgkmcnt(0)
    v_mfma_f32_16x16x32_bf16 v[80:83], v[72:75], v[16:19], 0
    v_mfma_f32_16x16x32_bf16 v[84:87], v[72:75], v[20:23], 0
    v_mfma_f32_16x16x32_bf16 v[80:83], v[76:79], v[24:27], v[80:83]
    v_mfma_f32_16x16x32_bf16 v[84:87], v[76:79], v[28:31], v[84:87]
    s_nop 7
    v_cndmask_b32 v80, v80, v84, s[66:67]
    ds_write_b32 v13, v80
    s_waitcnt lgkmcnt(0)
    s_barrier
    s_cmp_eq_u32 s3, 0
    s_cbranch_scc0 LWother
    ds_read_b128 v[60:63], v14 offset:0
    ds_read_b128 v[64:67], v14 offset:1024
    s_waitcnt lgkmcnt(0)
    v_pk_add_f32 v[60:61], v[60:61], v[64:65]
    v_pk_add_f32 v[62:63], v[62:63], v[66:67]
    v_pk_add_f32 v[60:61], v[60:61], v[62:63]
    v_add_f32 v60, v60, v61
    global_store_dword v4, v60, s[42:43] sc1
LWend:
    s_endpgm
LWother:
    s_cmp_ge_u32 s3, 6
    s_cbranch_scc0 LroleR
    s_sleep 3
    global_load_dword v126, v7, s[32:33]
LroleR:
    s_and_b32 s9, s13, 3
    s_lshl_b32 s9, s9, 3
    s_add_u32 s9, s9, s3
    s_cmp_eq_u32 s9, 4
    s_cbranch_scc0 LRend
    s_lshr_b32 s13, s13, 2
    s_and_b32 s11, s4, 0xe0
    s_lshl_b32 s11, s11, 3
    s_add_u32 s11, s11, 202752
    s_load_dword s9, s[42:43], s11 glc
    s_waitcnt lgkmcnt(0)
    s_add_u32 s9, s9, 1
    s_lshr_b32 s14, s9, 7
    s_and_b32 s9, s9, 0xff
    s_cmp_gt_u32 s14, s9
    s_cselect_b32 s14, 0x2000, 0
    v_bfe_u32 v4, v0, 4, 1
    v_bfe_u32 v1, v0, 5, 1
    v_lshl_add_u32 v4, v4, 1, v1
    v_and_b32 v12, 3, v0
    v_lshl_add_u32 v4, v12, 2, v4
    s_lshl_b32 s9, s13, 4
    v_add_u32 v4, s9, v4
    v_lshlrev_b32 v3, 1, v4
    v_lshl_add_u32 v6, v4, 2, s14
    v_and_b32 v5, -8, v6
    v_add_u32 v5, 661504, v5
    v_add_u32 v6, 200704, v6
    v_cmp_gt_u32 vcc, 32, v0
    s_nop 1
    v_cndmask_b32 v7, 0, 16, vcc
    s_lshr_b32 s9, s13, 2
    s_mul_i32 s9, s9, 43
    v_lshrrev_b32 v8, 2, v0
    v_add_u32 v8, s9, v8
    v_add_u32 v9, 16, v8
    v_add_u32 v10, 32, v8
    v_cmp_gt_u32 s[62:63], 44, v0
    s_nop 1
    v_cndmask_b32 v10, v8, v10, s[62:63]
    s_and_b32 s9, s13, 3
    s_lshl_b32 s9, s9, 6
    s_add_u32 s9, s9, s14
    s_add_u32 s9, s9, 245760
    v_lshl_add_u32 v12, v12, 4, s9
    v_and_b32 v1, -32, v8
    v_add_u32 v8, v8, v1
    v_lshl_add_u32 v8, v8, 8, v12
    v_and_b32 v1, -32, v9
    v_add_u32 v9, v9, v1
    v_lshl_add_u32 v9, v9, 8, v12
    v_and_b32 v1, -32, v10
    v_add_u32 v10, v10, v1
    v_lshl_add_u32 v10, v10, 8, v12
    s_mov_b32 s15, 0
Lpoll_12:
    global_load_dwordx2 v[16:17], v5, s[42:43] sc1
    s_waitcnt vmcnt(0)
    v_cmp_ne_u32 vcc, s7, v17
    s_nop 0
    s_and_b64 exec, exec, vcc
    s_cbranch_scc0 Lpoll_12_ok
    s_add_u32 s15, s15, 1
    s_cmp_lt_u32 s15, 131072
    s_sleep 2
    s_cbranch_scc1 Lpoll_12
Lpoll_12_ok:
    s_mov_b64 exec, -1
    v_lshlrev_b32 v20, v7, v16
    v_and_b32 v20, 0xffff0000, v20
    s_mov_b32 s15, 0
Lpoll_13:
    global_load_dword v24, v6, s[42:43] sc1
    s_waitcnt vmcnt(0)
    v_cmp_eq_u32 vcc, -1, v24
    s_nop 0
    s_and_b64 exec, exec, vcc
    s_cbranch_scc0 Lpoll_13_ok
    s_add_u32 s15, s15, 1
    s_cmp_lt_u32 s15, 131072
    s_sleep 1
    s_cbranch_scc1 Lpoll_13
Lpoll_13_ok:
    s_mov_b64 exec, -1
    s_cmp_eq_u32 s13, 0
    s_cbranch_scc0 LRnoep
    s_mov_b64 exec, 1
    v_mov_b32 v2, 0
    v_mov_b32 v4, s7
    global_store_dword v2, v4, s[42:43] offset:0 sc1
    s_mov_b64 exec, -1
LRnoep:
    s_sleep 4
    global_load_dwordx4 v[32:35], v8, s[42:43] sc1
    global_load_dwordx4 v[36:39], v9, s[42:43] sc1
    global_load_dwordx4 v[40:43], v10, s[42:43] sc1
    s_mov_b32 s15, 0
Lfast_14:
    s_waitcnt vmcnt(0)
Lfast_14_in:
    v_pk_add_f32 v[44:45], v[32:33], v[36:37]
    v_pk_add_f32 v[46:47], v[34:35], v[38:39]
    s_mov_b64 exec, s[62:63]
    v_pk_add_f32 v[44:45], v[44:45], v[40:41]
    v_pk_add_f32 v[46:47], v[46:47], v[42:43]
    s_mov_b64 exec, -1
    v_permlane32_swap_b32 v44, v45
    v_permlane32_swap_b32 v46, v47
    v_add_f32 v44, v44, v45
    v_add_f32 v46, v46, v47
    s_nop 1
    v_permlane16_swap_b32 v44, v46
Lpad_M_6:
    s_cbranch_execz Lpad_M_10
    v_add_f32 v44, v44, v46
    v_cmp_u_f32 vcc, v44, v44
    s_nop 0
    s_cbranch_vccz Lfast_14_ok
    v_max3_u32 v2, v32, v33, v34
    v_max3_u32 v2, v2, v35, v36
    v_max3_u32 v2, v2, v37, v38
    v_max3_u32 v2, v2, v39, v40
    v_max3_u32 v2, v2, v41, v42
    v_max_u32 v2, v2, v43
    v_cmp_eq_u32 vcc, -1, v2
    s_nop 0
    s_cbranch_vccz Lfast_14_ok
    s_mov_b64 exec, vcc
    global_load_dwordx4 v[32:35], v8, s[42:43] sc1
    global_load_dwordx4 v[36:39], v9, s[42:43] sc1
    global_load_dwordx4 v[40:43], v10, s[42:43] sc1
    s_mov_b64 exec, -1
    s_add_u32 s15, s15, 1
    s_cmp_lt_u32 s15, 131072
    s_cbranch_scc1 Lfast_14
    s_waitcnt vmcnt(0)
Lfast_14_ok:
    v_add_f32_dpp v44, v44, v44 row_ror:4 row_mask:0xf bank_mask:0xf
    s_nop 1
    v_add_f32_dpp v44, v44, v44 row_ror:8 row_mask:0xf bank_mask:0xf
    v_cvt_pk_bf16_f32 v44, 0, v44
    v_mul_f32 v44, v44, v20
    v_cvt_pk_bf16_f32 v44, 0, v44
    v_add_f32 v44, v44, v24
    v_cvt_pk_bf16_f32 v44, v44, v44
    s_mov_b32 exec_lo, 0x000f000f
    s_mov_b32 exec_hi, 0x000f000f
    global_store_short v3, v44, s[38:39]
LRend:
    s_endpgm
LroleU:
    s_bitcmp1_b32 s13, 0
    s_cselect_b64 s[52:53], s[30:31], s[28:29]
    s_cselect_b64 s[56:57], s[28:29], s[30:31]
    s_cselect_b32 s76, 4096, 0
    s_mov_b32 s54, 1409024
    s_mov_b32 s55, 0x20000
    s_mov_b32 s58, 1409024
    s_mov_b32 s59, 0x20000
    s_mov_b32 s72, s32
    s_mov_b32 s73, s33
    s_mov_b32 s74, 1409024
    s_mov_b32 s75, 0x20000
    v_lshrrev_b32 v1, 2, v0
    v_and_b32 v125, 8, v1
    v_xor_b32 v125, v125, v0
    v_bfe_u32 v124, v125, 2, 1
    v_bfe_u32 v1, v125, 3, 1
    v_lshl_add_u32 v124, v124, 1, v1
    v_lshrrev_b32 v1, 4, v0
    v_lshl_add_u32 v124, v1, 2, v124
    v_mul_u32_u24 v124, 2752, v124
    v_lshlrev_b32 v1, 1, v1
    v_xor_b32 v1, v1, v0
    v_and_b32 v1, 3, v1
    v_lshl_add_u32 v124, v1, 4, v124
    v_bfe_u32 v8, v0, 3, 1
    v_bfe_u32 v1, v0, 4, 1
    v_lshl_add_u32 v8, v8, 1, v1
    v_lshrrev_b32 v1, 5, v0
    v_lshl_add_u32 v8, v8, 3, v1
    v_mul_u32_u24 v8, 1024, v8
    v_lshlrev_b32 v1, 1, v1
    v_and_b32 v9, 7, v0
    v_xor_b32 v1, v1, v9
    v_lshl_add_u32 v8, v1, 4, v8
    v_xor_b32 v9, 64, v8
    s_lshl_b32 s12, s3, 12
    s_add_u32 s12, s12, 65536
    s_lshl_b32 s14, s3, 13
    s_lshl_b32 s11, s13, 15
    s_lshl_b32 s9, s3, 7
    s_add_u32 s11, s11, s9
    s_mul_i32 s70, s3, 176128
    s_lshl_b32 s9, s13, 6
    s_add_u32 s70, s70, s9
    s_mov_b32 s71, s70
    s_add_u32 s76, s76, s14
    s_xor_b32 s77, s76, 4096
    s_lshr_b32 s9, s3, 2
    s_lshl_b32 s9, s9, 10
    s_and_b32 s62, s3, 3
    s_lshl_b32 s62, s62, 2
    s_add_u32 s9, s9, s62
    v_add_u32 v14, 108032, v11
    v_add_u32 v13, s9, v14
    s_mov_b32 s66, 0xffff0000
    s_mov_b32 s67, 0xffff0000
    s_mov_b32 s68, 0
    s_mov_b32 s69, -1
    v_bfe_u32 v12, v0, 4, 1
    v_bfe_u32 v1, v0, 5, 1
    v_lshl_add_u32 v12, v12, 1, v1
    v_and_b32 v1, 15, v0
    v_lshl_add_u32 v12, v1, 2, v12
    s_lshl_b32 s9, s3, 6
    v_add_u32 v12, s9, v12
    v_cmp_gt_u32 vcc, 32, v0
    s_nop 1
    v_cndmask_b32 v7, 0, 16, vcc
    v_lshlrev_b32 v6, 2, v12
    v_and_b32 v5, -8, v6
    v_add_u32 v5, 657408, v5
    v_add_u32 v120, 200704, v6
    v_add_u32 v119, 208896, v6
    s_lshr_b32 s9, s3, 2
    s_lshl_b32 s9, s9, 14
    s_and_b32 s10, s3, 3
    s_lshl_b32 s10, s10, 11
    s_add_u32 s9, s9, s10
    s_add_u32 s9, s9, 212992
    v_add_u32 v116, s9, v11
    v_lshrrev_b32 v10, 4, v0
    s_lshl_b32 s9, s3, 5
    s_add_u32 s9, s9, 112128
    v_lshl_add_u32 v10, v10, 3, s9
    v_and_b32 v121, 15, v0
    v_lshlrev_b32 v121, 4, v121
    v_add_u32 v121, 112128, v121
    s_mul_i32 s9, s3, 43
    s_add_u32 s9, s9, s13
    s_and_b32 s10, s9, -32
    s_add_u32 s9, s9, s10
    s_lshl_b32 s9, s9, 8
    s_add_u32 s9, s9, 245760
    v_lshl_add_u32 v4, v0, 2, s9
    v_add_u32 v118, 0x2000, v4
    v_bfe_u32 v123, v0, 2, 2
    v_and_b32 v1, 2, v123
    v_lshrrev_b32 v122, 4, v0
    v_xor_b32 v122, v122, v1
    v_lshl_add_u32 v122, v123, 2, v122
    v_lshlrev_b32 v122, 6, v122
    v_and_b32 v1, 1, v123
    v_lshl_add_u32 v122, v1, 5, v122
    v_and_b32 v1, 3, v0
    v_lshl_add_u32 v122, v1, 3, v122
    v_add_u32 v122, s14, v122
    v_xor_b32 v123, 32, v122
    v_bfe_u32 v1, v0, 2, 2
    v_lshrrev_b32 v112, 4, v0
    v_lshl_add_u32 v112, v1, 2, v112
    v_lshlrev_b32 v112, 7, v112
    v_lshl_add_u32 v112, v1, 5, v112
    v_and_b32 v1, 3, v0
    v_lshl_add_u32 v112, v1, 3, v112
    v_add_u32 v112, s12, v112
    v_xor_b32 v113, 32, v112
    v_xor_b32 v114, 64, v112
    v_xor_b32 v115, 96, v112
    v_lshlrev_b32 v6, 1, v12
    global_load_ushort v64, v6, s[16:17]
    s_mov_b32 s15, 0
Lw_15:
    ds_read_b32 v1, v15 offset:16
    s_waitcnt lgkmcnt(0)
    v_readfirstlane_b32 s9, v1
    s_nop 0
    s_cmp_ge_u32 s9, 8
    s_cbranch_scc1 Lw_15_ok
    s_add_u32 s15, s15, 1
    s_cmp_lt_u32 s15, 524288
    s_sleep 1
    s_cbranch_scc1 Lw_15
Lw_15_ok:
    s_mov_b32 s10, s63
    s_mov_b32 s10, s63
    v_add_u32 v5, s10, v5
    v_add_u32 v116, s10, v116
    s_and_b32 s9, s4, 0xe0
    s_lshl_b32 s9, s9, 3
    s_add_u32 s9, s9, 196608
    v_lshl_add_u32 v6, v0, 2, s9
    s_mov_b32 s15, 0
LUs2:
    global_load_dword v86, v6, s[42:43] sc1
    s_waitcnt vmcnt(0)
    v_cmp_eq_u32 vcc, -1, v86
    s_nop 0
    s_bcnt1_i32_b64 s9, vcc
    s_cmp_le_u32 s9, 8
Lpad_M_7:
    s_cbranch_execz Lret_M
    s_cbranch_scc1 LUs2_ok
    s_sleep 3
    s_add_u32 s15, s15, 1
    s_cmp_lt_u32 s15, 131072
    s_cbranch_scc1 LUs2
LUs2_ok:
    s_setprio 2
    s_add_u32 m0, s76, 0
    s_nop 0
    buffer_load_dwordx4 v124, s[52:55], s70 offen  lds
    s_add_u32 s70, s70, 44032
    s_add_u32 m0, s76, 1024
    s_nop 0
    buffer_load_dwordx4 v124, s[52:55], s70 offen  lds
    s_add_u32 s70, s70, 44032
    s_add_u32 m0, s76, 2048
    s_nop 0
    buffer_load_dwordx4 v124, s[52:55], s70 offen  lds
    s_add_u32 s70, s70, 44032
    s_add_u32 m0, s76, 3072
    s_nop 0
    buffer_load_dwordx4 v124, s[52:55], s70 offen  lds
    s_add_u32 s70, s70, 44032
    s_setprio 1
    s_add_u32 m0, s77, 0
    s_nop 0
    buffer_load_dwordx4 v124, s[56:59], s71 offen  lds
    s_add_u32 s71, s71, 44032
    s_add_u32 m0, s77, 1024
    s_nop 0
    buffer_load_dwordx4 v124, s[56:59], s71 offen  lds
    s_add_u32 s71, s71, 44032
    s_add_u32 m0, s77, 2048
    s_nop 0
    buffer_load_dwordx4 v124, s[56:59], s71 offen  lds
    s_add_u32 s71, s71, 44032
    s_add_u32 m0, s77, 3072
    s_nop 0
    buffer_load_dwordx4 v124, s[56:59], s71 offen  lds
    s_add_u32 s71, s71, 44032
    s_setprio 0
    s_barrier
    global_load_dwordx2 v[80:81], v5, s[42:43] offset:-2048 sc1
    global_load_dwordx2 v[82:83], v5, s[42:43] sc1
    global_load_dwordx2 v[84:85], v5, s[42:43] offset:2048 sc1
    global_load_dword v86, v6, s[42:43] sc1
    s_waitcnt vmcnt(4)
    ds_read_b64_tr_b16 v[16:17], v122 offset:0
    ds_read_b64_tr_b16 v[18:19], v122 offset:1024
    ds_read_b64_tr_b16 v[20:21], v123 offset:0
    ds_read_b64_tr_b16 v[22:23], v123 offset:1024
    ds_read_b64_tr_b16 v[32:33], v122 offset:2048
    ds_read_b64_tr_b16 v[34:35], v122 offset:3072
    ds_read_b64_tr_b16 v[36:37], v123 offset:2048
    ds_read_b64_tr_b16 v[38:39], v123 offset:3072
    ds_read_b64_tr_b16 v[24:25], v122 offset:4096
    ds_read_b64_tr_b16 v[26:27], v122 offset:5120
    ds_read_b64_tr_b16 v[28:29], v123 offset:4096
    ds_read_b64_tr_b16 v[30:31], v123 offset:5120
    ds_read_b64_tr_b16 v[40:41], v122 offset:6144
    ds_read_b64_tr_b16 v[42:43], v122 offset:7168
    ds_read_b64_tr_b16 v[44:45], v123 offset:6144
    ds_read_b64_tr_b16 v[46:47], v123 offset:7168
    s_mov_b32 s15, 0
LUs3:
    s_waitcnt vmcnt(0)
    v_cmp_eq_u32 vcc, -1, v86
    s_nop 0
    s_cbranch_vccz LUs3_ok
    s_sleep 2
    global_load_dword v86, v6, s[42:43] sc1
    s_add_u32 s15, s15, 1
    s_cmp_lt_u32 s15, 131072
    s_cbranch_scc1 LUs3
LUs3_ok:
    global_load_dwordx4 v[48:51], v116, s[42:43] offset:0 sc1
    global_load_dwordx4 v[52:55], v116, s[42:43] offset:1024 sc1
LUs3_go:
    s_mov_b32 s15, 0
LUs1:
    v_xor_b32 v2, s7, v81
    v_xor_b32 v3, s7, v83
    v_or_b32 v2, v2, v3
    v_xor_b32 v3, s7, v85
    v_or_b32 v2, v2, v3
    v_cmp_ne_u32 vcc, 0, v2
    s_nop 0
    s_cbranch_vccz LUs1_ok
    global_load_dwordx2 v[80:81], v5, s[42:43] offset:-2048 sc1
    global_load_dwordx2 v[82:83], v5, s[42:43] sc1
    global_load_dwordx2 v[84:85], v5, s[42:43] offset:2048 sc1
    global_load_dwordx4 v[48:51], v116, s[42:43] offset:0 sc1
    global_load_dwordx4 v[52:55], v116, s[42:43] offset:1024 sc1
    s_waitcnt vmcnt(2)
    s_add_u32 s15, s15, 1
    s_cmp_lt_u32 s15, 131072
    s_cbranch_scc1 LUs1
LUs1_ok:
    v_lshlrev_b32 v64, 16, v64
    v_lshlrev_b32 v65, v7, v80
    v_and_b32 v65, 0xffff0000, v65
    v_lshlrev_b32 v66, v7, v82
    v_and_b32 v66, 0xffff0000, v66
    v_lshlrev_b32 v67, v7, v84
    v_and_b32 v67, 0xffff0000, v67
    v_add_f32 v67, 1.0, v67
    v_cvt_pk_bf16_f32 v67, 0, v67
    s_mov_b32 s15, 0
Lfast_16:
    s_waitcnt vmcnt(0)
Lfast_16_in:
    v_pk_add_f32 v[68:69], v[48:49], v[52:53]
    v_pk_add_f32 v[70:71], v[50:51], v[54:55]
    s_nop 0
    v_permlane32_swap_b32 v68, v69
    v_permlane32_swap_b32 v70, v71
    v_add_f32 v68, v68, v69
    v_add_f32 v70, v70, v71
    s_nop 1
    v_permlane16_swap_b32 v68, v70
    v_add_f32 v68, v68, v70
    v_cmp_u_f32 vcc, v68, v68
    s_nop 0
    s_cbranch_vccz Lfast_16_ok
    v_max3_u32 v2, v48, v49, v50
    v_max3_u32 v2, v2, v51, v52
    v_max3_u32 v2, v2, v53, v54
    v_max_u32 v2, v2, v55
    v_cmp_eq_u32 vcc, -1, v2
    s_nop 0
    s_cbranch_vccz Lfast_16_ok
    s_mov_b64 exec, vcc
    global_load_dwordx4 v[48:51], v116, s[42:43] offset:0 sc1
    global_load_dwordx4 v[52:55], v116, s[42:43] offset:1024 sc1
    s_mov_b64 exec, -1
    s_add_u32 s15, s15, 1
    s_cmp_lt_u32 s15, 131072
    s_cbranch_scc1 Lfast_16
    s_waitcnt vmcnt(0)
Lfast_16_ok:
    v_cvt_pk_bf16_f32 v68, 0, v68
    v_mul_f32 v68, v68, v65
    v_cvt_pk_bf16_f32 v68, 0, v68
    v_add_f32 v68, v68, v64
    v_cvt_pk_bf16_f32 v68, 0, v68
    s_nop 1
    v_subrev_f32_dpp v2, v68, v68 row_newbcast:0 row_mask:0xf bank_mask:0xf
    v_mul_f32 v3, v2, v2
    s_nop 0
    v_add_f32_dpp v2, v2, v2 row_ror:1 row_mask:0xf bank_mask:0xf
    v_add_f32_dpp v3, v3, v3 row_ror:1 row_mask:0xf bank_mask:0xf
    s_nop 0
    v_add_f32_dpp v2, v2, v2 row_ror:2 row_mask:0xf bank_mask:0xf
    v_add_f32_dpp v3, v3, v3 row_ror:2 row_mask:0xf bank_mask:0xf
    s_nop 0
    v_add_f32_dpp v2, v2, v2 row_ror:4 row_mask:0xf bank_mask:0xf
    v_add_f32_dpp v3, v3, v3 row_ror:4 row_mask:0xf bank_mask:0xf
    s_nop 0
    v_add_f32_dpp v2, v2, v2 row_ror:8 row_mask:0xf bank_mask:0xf
    v_add_f32_dpp v3, v3, v3 row_ror:8 row_mask:0xf bank_mask:0xf
    v_mul_f32 v70, 0x3d800000, v2
    v_fma_f32 v3, -v70, v2, v3
    s_nop 0
    v_add_f32_dpp v2, v68, v70 row_newbcast:0 row_mask:0xf bank_mask:0xf
    ds_write_b64 v10, v[2:3]
    s_add_u32 m0, s12, 0
    s_nop 0
    buffer_load_dwordx4 v8, s[72:75], s11 offen nt lds
    s_add_u32 s11, s11, 2048
    s_add_u32 m0, s12, 1024
    s_nop 0
    buffer_load_dwordx4 v9, s[72:75], s11 offen nt lds
    s_add_u32 s11, s11, 2048
    v_mov_b32 v69, v68
    s_waitcnt lgkmcnt(0)
    s_barrier
    ds_read_b128 v[72:75], v121
Lpad_M_8:
    s_cbranch_execz Lret_M
    s_add_u32 m0, s12, 2048
    s_nop 0
    buffer_load_dwordx4 v8, s[72:75], s11 offen nt lds
    s_add_u32 s11, s11, 2048
    s_add_u32 m0, s12, 3072
    s_nop 0
    buffer_load_dwordx4 v9, s[72:75], s11 offen nt lds
    s_add_u32 s11, s11, 2048
    s_waitcnt lgkmcnt(0)
    v_subrev_f32_dpp v70, v72, v72 row_newbcast:0 row_mask:0xf bank_mask:0xf
    v_subrev_f32_dpp v71, v72, v74 row_newbcast:0 row_mask:0xf bank_mask:0xf
    v_add_f32 v3, v73, v75
    v_add_f32 v2, v70, v71
    v_mul_f32 v70, v70, v70
    v_fmac_f32 v70, v71, v71
    v_fmac_f32 v3, 0x41800000, v70
    v_add_f32_dpp v2, v2, v2 row_ror:1 row_mask:0xf bank_mask:0xf
    s_nop 0
    v_add_f32_dpp v3, v3, v3 row_ror:1 row_mask:0xf bank_mask:0xf
    v_add_f32_dpp v2, v2, v2 row_ror:2 row_mask:0xf bank_mask:0xf
    s_nop 0
    v_add_f32_dpp v3, v3, v3 row_ror:2 row_mask:0xf bank_mask:0xf
    v_add_f32_dpp v2, v2, v2 row_ror:4 row_mask:0xf bank_mask:0xf
    s_nop 0
    v_add_f32_dpp v3, v3, v3 row_ror:4 row_mask:0xf bank_mask:0xf
    v_add_f32_dpp v2, v2, v2 row_ror:8 row_mask:0xf bank_mask:0xf
    s_nop 0
    v_add_f32_dpp v3, v3, v3 row_ror:8 row_mask:0xf bank_mask:0xf
    v_mul_f32 v2, 0x3d000000, v2
    v_mul_f32 v3, 0x3b000000, v3
    v_fma_f32 v3, -v2, v2, v3
    v_add_f32_dpp v2, v72, v2 row_newbcast:0 row_mask:0xf bank_mask:0xf
    v_max_f32 v3, 0, v3
    v_cvt_pk_bf16_f32 v3, 0, v3
    v_cvt_pk_bf16_f32 v2, 0, v2
    v_add_f32 v3, 0x3727c5ac, v3
    v_sub_f32 v68, v68, v2
    v_cvt_pk_bf16_f32 v3, 0, v3
    v_cvt_pk_bf16_f32 v68, 0, v68
    v_sqrt_f32 v3, v3
    s_nop 0
    v_cvt_pk_bf16_f32 v3, 0, v3
    v_rcp_f32 v3, v3
    s_nop 0
    v_mul_f32 v68, v68, v3
    v_cvt_pk_bf16_f32 v68, 0, v68
    v_mul_f32 v68, v68, v67
    v_cvt_pk_bf16_f32 v68, 0, v68
    v_add_f32 v68, v68, v66
    s_nop 1
    v_mov_b32_dpp v73, v68 row_shl:1 row_mask:0xf bank_mask:0xf
    v_cvt_pk_bf16_f32 v68, v68, v73
    s_nop 1
    v_mov_b32_dpp v72, v68 row_newbcast:0 row_mask:0xf bank_mask:0xf
    v_mov_b32_dpp v73, v68 row_newbcast:2 row_mask:0xf bank_mask:0xf
    v_mov_b32_dpp v74, v68 row_newbcast:4 row_mask:0xf bank_mask:0xf
    v_mov_b32_dpp v75, v68 row_newbcast:6 row_mask:0xf bank_mask:0xf
    v_mov_b32_dpp v76, v68 row_newbcast:8 row_mask:0xf bank_mask:0xf
    v_mov_b32_dpp v77, v68 row_newbcast:10 row_mask:0xf bank_mask:0xf
    v_mov_b32_dpp v78, v68 row_newbcast:12 row_mask:0xf bank_mask:0xf
    v_mov_b32_dpp v79, v68 row_newbcast:14 row_mask:0xf bank_mask:0xf
    v_mfma_f32_16x16x32_bf16 v[80:83], v[72:75], v[16:19], 0
    v_mfma_f32_16x16x32_bf16 v[84:87], v[72:75], v[20:23], 0
    v_mfma_f32_16x16x32_bf16 v[88:91], v[72:75], v[24:27], 0
    v_mfma_f32_16x16x32_bf16 v[92:95], v[72:75], v[28:31], 0
    v_mfma_f32_16x16x32_bf16 v[80:83], v[76:79], v[32:35], v[80:83]
    v_mfma_f32_16x16x32_bf16 v[84:87], v[76:79], v[36:39], v[84:87]
    v_mfma_f32_16x16x32_bf16 v[88:91], v[76:79], v[40:43], v[88:91]
    v_mfma_f32_16x16x32_bf16 v[92:95], v[76:79], v[44:47], v[92:95]
    s_cmp_eq_u32 s13, 0
    s_cbranch_scc0 LUnox2
    global_store_dword v120, v69, s[42:43] sc1
    global_store_dword v119, v69, s[42:43] sc1
LUnox2:
    s_nop 3
    v_cndmask_b32 v80, v80, v84, s[66:67]
    s_nop 0
    v_cndmask_b32 v88, v88, v92, s[66:67]
    v_cndmask_b32 v80, v80, v88, s[68:69]
    ds_write_b32 v13, v80 offset:0
    s_waitcnt lgkmcnt(0)
    s_barrier
    ds_read_b128 v[64:67], v14
    ds_read_b128 v[68:71], v14 offset:1024
    s_waitcnt vmcnt(2)
    s_cbranch_scc1 LUdown
    s_waitcnt vmcnt(0)
LUdown:
    ds_read_b64_tr_b16 v[96:97], v112 offset:0
    ds_read_b64_tr_b16 v[98:99], v112 offset:2048
    ds_read_b64_tr_b16 v[100:101], v113 offset:0
    ds_read_b64_tr_b16 v[102:103], v113 offset:2048
    ds_read_b64_tr_b16 v[104:105], v114 offset:0
    ds_read_b64_tr_b16 v[106:107], v114 offset:2048
    ds_read_b64_tr_b16 v[108:109], v115 offset:0
    ds_read_b64_tr_b16 v[110:111], v115 offset:2048
    s_waitcnt lgkmcnt(8)
    v_pk_add_f32 v[64:65], v[64:65], v[68:69]
    v_pk_add_f32 v[66:67], v[66:67], v[70:71]
    v_pk_add_f32 v[64:65], v[64:65], v[66:67]
    v_add_f32 v64, v64, v65
    v_cvt_pk_bf16_f32 v64, 0, v64
    v_mov_b32 v65, v64
    s_nop 1
    v_permlane32_swap_b32 v64, v65
    v_mul_f32 v64, v64, v65
    s_nop 1
    v_mov_b32_dpp v65, v64 row_shl:1 row_mask:0xf bank_mask:0xf
    v_cvt_pk_bf16_f32 v64, v64, v65
    s_nop 1
    v_mov_b32_dpp v64, v64 row_shl:8 row_mask:0xc bank_mask:0xf
    s_nop 1
    v_mov_b32_dpp v68, v64 row_newbcast:0 row_mask:0xf bank_mask:0xf
    v_mov_b32_dpp v69, v64 row_newbcast:2 row_mask:0xf bank_mask:0xf
    v_mov_b32_dpp v70, v64 row_newbcast:4 row_mask:0xf bank_mask:0xf
    v_mov_b32_dpp v71, v64 row_newbcast:6 row_mask:0xf bank_mask:0xf
    s_waitcnt lgkmcnt(0)
    s_nop 0
    v_mfma_f32_16x16x32_bf16 v[80:83], v[68:71], v[96:99], 0
    v_mfma_f32_16x16x32_bf16 v[84:87], v[68:71], v[100:103], 0
    v_mfma_f32_16x16x32_bf16 v[88:91], v[68:71], v[104:107], 0
    v_mfma_f32_16x16x32_bf16 v[92:95], v[68:71], v[108:111], 0
    s_nop 5
    v_cndmask_b32 v80, v80, v84, s[66:67]
    s_nop 0
    v_cndmask_b32 v88, v88, v92, s[66:67]
    v_cndmask_b32 v80, v80, v88, s[68:69]
    global_store_dword v4, v80, s[42:43] sc1
    global_store_dword v118, v80, s[42:43] sc1
    s_endpgm
LroleM:
    s_mov_b32 s52, s36
    s_mov_b32 s53, s37
    s_mov_b32 s54, 3145728
    s_mov_b32 s55, 0x20000
    v_bfe_u32 v8, v0, 3, 1
    v_bfe_u32 v1, v0, 4, 1
    v_lshl_add_u32 v8, v8, 1, v1
    v_lshrrev_b32 v1, 5, v0
    v_lshl_add_u32 v8, v1, 2, v8
    v_mul_u32_u24 v8, 6144, v8
    v_lshlrev_b32 v1, 1, v1
    v_and_b32 v9, 7, v0
    v_xor_b32 v1, v1, v9
    v_lshl_add_u32 v8, v1, 4, v8
    v_xor_b32 v9, 64, v8
    s_lshl_b32 s12, s3, 13
    s_mul_i32 s11, s3, 393216
    s_lshl_b32 s9, s13, 7
    s_add_u32 s11, s11, s9
    v_bfe_u32 v12, v0, 4, 1
    v_bfe_u32 v1, v0, 5, 1
    v_lshl_add_u32 v12, v12, 1, v1
    v_and_b32 v1, 15, v0
    v_lshl_add_u32 v12, v1, 2, v12
    s_lshl_b32 s9, s3, 6
    v_add_u32 v12, s9, v12
    v_cmp_gt_u32 vcc, 32, v0
    s_nop 1
    v_cndmask_b32 v7, 0, 16, vcc
    v_lshlrev_b32 v6, 1, v12
Lpad_M_9:
    s_cbranch_execz Lret_M
    s_mov_b32 s15, 0
Lw_17:
    ds_read_b32 v1, v15 offset:4
    s_waitcnt lgkmcnt(0)
    v_readfirstlane_b32 s9, v1
    s_nop 0
    s_cmp_ge_u32 s9, 16
    s_cbranch_scc1 Lw_17_ok
    s_add_u32 s15, s15, 1
    s_cmp_lt_u32 s15, 524288
    s_sleep 1
    s_cbranch_scc1 Lw_17
Lw_17_ok:
    global_load_ushort v48, v6, s[34:35]
    s_add_u32 m0, s12, 0
    s_nop 0
    buffer_load_dwordx4 v8, s[52:55], s11 offen nt lds
    s_add_u32 s11, s11, 49152
    s_add_u32 m0, s12, 1024
    s_nop 0
    buffer_load_dwordx4 v9, s[52:55], s11 offen nt lds
    s_add_u32 s11, s11, 49152
    s_add_u32 m0, s12, 2048
    s_nop 0
    buffer_load_dwordx4 v8, s[52:55], s11 offen nt lds
    s_add_u32 s11, s11, 49152
    s_add_u32 m0, s12, 3072
    s_nop 0
    buffer_load_dwordx4 v9, s[52:55], s11 offen nt lds
    s_add_u32 s11, s11, 49152
    s_add_u32 m0, s12, 4096
    s_nop 0
    buffer_load_dwordx4 v8, s[52:55], s11 offen nt lds
    s_add_u32 s11, s11, 49152
    s_add_u32 m0, s12, 5120
    s_nop 0
    buffer_load_dwordx4 v9, s[52:55], s11 offen nt lds
    s_add_u32 s11, s11, 49152
    s_add_u32 m0, s12, 6144
    s_nop 0
    buffer_load_dwordx4 v8, s[52:55], s11 offen nt lds
    s_add_u32 s11, s11, 49152
    s_add_u32 m0, s12, 7168
    s_nop 0
    buffer_load_dwordx4 v9, s[52:55], s11 offen nt lds
    s_add_u32 s11, s11, 49152
    v_bfe_u32 v1, v0, 2, 2
    v_lshrrev_b32 v100, 4, v0
    v_lshl_add_u32 v100, v1, 2, v100
    v_lshlrev_b32 v100, 7, v100
    v_lshl_add_u32 v100, v1, 5, v100
    v_and_b32 v1, 3, v0
    v_lshl_add_u32 v100, v1, 3, v100
    v_add_u32 v100, s12, v100
    v_xor_b32 v101, 32, v100
    v_xor_b32 v102, 64, v100
    v_xor_b32 v103, 96, v100
    s_lshr_b32 s9, s3, 2
    s_lshl_b32 s9, s9, 10
    s_and_b32 s62, s3, 3
    s_lshl_b32 s62, s62, 2
    s_add_u32 s9, s9, s62
    v_add_u32 v14, 108032, v11
    v_add_u32 v13, s9, v14
    s_mov_b32 s66, 0xffff0000
    s_mov_b32 s67, 0xffff0000
    s_mov_b32 s68, 0
    s_mov_b32 s69, -1
    s_lshl_b32 s10, s13, 8
    s_add_u32 s10, s10, 651264
    v_lshl_add_u32 v6, v0, 2, s10
    v_add_u32 v5, 0x2000, v6
    v_mov_b32 v69, s7
    s_waitcnt vmcnt(8)
    v_lshlrev_b32 v48, 16, v48
    v_mul_f32 v49, 0xbfb8aa3b, v48
    v_min_f32 v49, 0x42fc0000, v49
    v_exp_f32 v49, v49
    s_nop 0
    v_add_f32 v49, 1.0, v49
    v_rcp_f32 v50, v49
    s_nop 0
    v_mul_f32 v56, v48, v50
    v_fma_f32 v48, -v56, v49, v48
    v_fmac_f32 v56, v48, v50
    s_nop 1
    v_mov_b32_dpp v73, v56 row_shl:1 row_mask:0xf bank_mask:0xf
    v_cvt_pk_bf16_f32 v56, v56, v73
    s_nop 1
    v_mov_b32_dpp v72, v56 row_newbcast:0 row_mask:0xf bank_mask:0xf
    v_mov_b32_dpp v73, v56 row_newbcast:2 row_mask:0xf bank_mask:0xf
    v_mov_b32_dpp v74, v56 row_newbcast:4 row_mask:0xf bank_mask:0xf
    v_mov_b32_dpp v75, v56 row_newbcast:6 row_mask:0xf bank_mask:0xf
    v_mov_b32_dpp v76, v56 row_newbcast:8 row_mask:0xf bank_mask:0xf
    v_mov_b32_dpp v77, v56 row_newbcast:10 row_mask:0xf bank_mask:0xf
    v_mov_b32_dpp v78, v56 row_newbcast:12 row_mask:0xf bank_mask:0xf
    v_mov_b32_dpp v79, v56 row_newbcast:14 row_mask:0xf bank_mask:0xf
    s_waitcnt vmcnt(0)
    ds_read_b64_tr_b16 v[16:17], v100 offset:0
    ds_read_b64_tr_b16 v[18:19], v100 offset:2048
    ds_read_b64_tr_b16 v[20:21], v101 offset:0
    ds_read_b64_tr_b16 v[22:23], v101 offset:2048
    ds_read_b64_tr_b16 v[24:25], v102 offset:0
    ds_read_b64_tr_b16 v[26:27], v102 offset:2048
    ds_read_b64_tr_b16 v[28:29], v103 offset:0
    ds_read_b64_tr_b16 v[30:31], v103 offset:2048
    ds_read_b64_tr_b16 v[32:33], v100 offset:4096
    ds_read_b64_tr_b16 v[34:35], v100 offset:6144
    ds_read_b64_tr_b16 v[36:37], v101 offset:4096
    ds_read_b64_tr_b16 v[38:39], v101 offset:6144
    ds_read_b64_tr_b16 v[40:41], v102 offset:4096
    ds_read_b64_tr_b16 v[42:43], v102 offset:6144
    ds_read_b64_tr_b16 v[44:45], v103 offset:4096
    ds_read_b64_tr_b16 v[46:47], v103 offset:6144
    s_waitcnt lgkmcnt(0)
    v_mfma_f32_16x16x32_bf16 v[80:83], v[72:75], v[16:19], 0
    v_mfma_f32_16x16x32_bf16 v[84:87], v[72:75], v[20:23], 0
    v_mfma_f32_16x16x32_bf16 v[88:91], v[72:75], v[24:27], 0
    v_mfma_f32_16x16x32_bf16 v[92:95], v[72:75], v[28:31], 0
    v_mfma_f32_16x16x32_bf16 v[80:83], v[76:79], v[32:35], v[80:83]
    v_mfma_f32_16x16x32_bf16 v[84:87], v[76:79], v[36:39], v[84:87]
    v_mfma_f32_16x16x32_bf16 v[88:91], v[76:79], v[40:43], v[88:91]
    v_mfma_f32_16x16x32_bf16 v[92:95], v[76:79], v[44:47], v[92:95]
    s_nop 5
    v_cndmask_b32 v80, v80, v84, s[66:67]
    s_nop 0
    v_cndmask_b32 v88, v88, v92, s[66:67]
    v_cndmask_b32 v80, v80, v88, s[68:69]
    ds_write_b32 v13, v80 offset:0
    s_waitcnt lgkmcnt(0)
    s_barrier
    s_cmp_eq_u32 s3, 0
    s_cbranch_scc0 LMend
    ds_read_b128 v[60:63], v14 offset:0
    ds_read_b128 v[64:67], v14 offset:1024
    s_waitcnt lgkmcnt(0)
    v_pk_add_f32 v[60:61], v[60:61], v[64:65]
    v_pk_add_f32 v[62:63], v[62:63], v[66:67]
    v_pk_add_f32 v[60:61], v[60:61], v[62:63]
    v_add_f32 v60, v60, v61
    s_nop 1
    v_mov_b32_dpp v61, v60 row_shl:1 row_mask:0xf bank_mask:0xf
    v_cvt_pk_bf16_f32 v68, v60, v61
    s_mov_b32 exec_lo, 0x55555555
    s_mov_b32 exec_hi, 0x55555555
    global_store_dwordx2 v6, v[68:69], s[42:43] sc1
    global_store_dwordx2 v5, v[68:69], s[42:43] sc1
LMend:
    s_endpgm
Lcheck:
    s_getreg_b32 s10, hwreg(HW_REG_XCC_ID, 0, 4)
    s_lshl_b32 s11, s7, 4
    s_or_b32 s11, s11, s10
    s_and_b32 s9, s4, 0xe0
    s_add_u32 s9, s9, 256
    v_add_u32 v12, s9, v0
    v_and_b32 v3, 31, v0
    v_add_u32 v3, 128, v3
    v_mov_b32 v13, s11
    v_mov_b32 v5, s7
    v_cmp_gt_u32 vcc, 32, v0
    s_nop 1
    v_cndmask_b32 v12, v3, v12, vcc
    v_cndmask_b32 v13, v5, v13, vcc
    v_lshlrev_b32 v12, 7, v12
    global_load_dword v14, v12, s[42:43] sc1
Lpad_M_10:
    s_cbranch_execz Lret_M
    s_branch Lnoss
    s_mov_b32 s15, 0
Lcheck1:
    global_load_dword v14, v12, s[42:43] sc1
Lcheck1b:
    s_waitcnt vmcnt(0)
    v_cmp_ne_u32 vcc, v13, v14
    s_add_u32 s15, s15, 1
    s_cbranch_vccz Lcheck2
    s_cmp_eq_u32 vcc_hi, 0
    s_cselect_b32 s9, 3, 131072
    s_cmp_lt_u32 s15, s9
    s_sleep 4
    s_cbranch_scc1 Lcheck1
Lcheck2:
    s_cmp_eq_u32 vcc_lo, 0
    s_cselect_b32 s9, 3, 2
    s_mov_b64 exec, 1
    v_mov_b32 v1, s9
    ds_add_u32 v15, v1 offset:12
    s_mov_b64 exec, -1
    s_branch Lqwait
Lskip49:
    s_cmp_eq_u32 s8, 1
    s_cbranch_scc1 Lld49_1
    s_cmp_eq_u32 s8, 2
    s_cbranch_scc1 Lld49_2
    s_cmp_eq_u32 s8, 3
    s_cbranch_scc1 Lld49_3
    s_cmp_eq_u32 s8, 4
    s_cbranch_scc1 Lld49_4
    s_cmp_eq_u32 s8, 5
    s_cbranch_scc1 Lld49_5
    s_cmp_eq_u32 s8, 6
    s_cbranch_scc1 Lld49_6
    s_cmp_eq_u32 s8, 7
    s_cbranch_scc1 Lld49_7
    s_cmp_eq_u32 s8, 8
    s_cbranch_scc1 Lld49_8
    s_cmp_eq_u32 s8, 9
    s_cbranch_scc1 Lld49_9
    s_branch Lld49_10
Lquick:
    s_mov_b32 s15, 0
Lquick1:
    ds_read_b64 v[2:3], v15 offset:0
    s_waitcnt lgkmcnt(0)
    v_readfirstlane_b32 s9, v2
    v_readfirstlane_b32 s10, v3
    s_nop 0
    s_cmp_ge_u32 s10, 8
    s_cbranch_scc1 Lnotquick
    s_add_u32 s15, s15, 1
    s_cmp_ge_u32 s15, 524288
    s_cbranch_scc1 Lnotquick
    s_cmp_ge_u32 s9, 4
    s_sleep 2
    s_cbranch_scc0 Lquick1
    s_mov_b32 s58, 16
    s_branch LafterV
Lreport:
    s_setprio 3
    s_load_dword s7, s[42:43], 0
    s_waitcnt lgkmcnt(0)
    s_add_u32 s11, s7, 1
    s_getreg_b32 s10, hwreg(HW_REG_XCC_ID, 0, 4)
    s_lshl_b32 s9, s11, 4
    s_or_b32 s9, s9, s10
    s_lshl_b32 s10, s4, 7
    s_add_u32 s10, s10, 32768
    v_mov_b32 v2, s10
    v_mov_b32 v3, s9
    s_mov_b64 exec, 1
    global_store_dword v2, v3, s[42:43] sc1
    s_mov_b64 exec, -1
    s_setprio 0
    s_branch Lreported
Llower:
    s_cmp_eq_u32 s5, 0
    s_cbranch_scc0 Lnosent
    s_add_u32 s9, s4, s3
    s_mul_i32 s9, s9, 1408
    s_add_u32 s9, s9, 65536
    v_add_u32 v6, s9, v11
    v_mov_b32 v2, -1
    v_mov_b32 v3, -1
    v_mov_b32 v4, -1
    v_mov_b32 v5, -1
    s_load_dword s7, s[42:43], 0
    s_mov_b32 s15, 0
Lw_18:
    ds_read_b32 v1, v15 offset:20
    s_waitcnt lgkmcnt(0)
    v_readfirstlane_b32 s9, v1
    s_nop 0
    s_cmp_ge_u32 s9, 8
    s_cbranch_scc1 Lw_18_ok
    s_add_u32 s15, s15, 1
    s_cmp_lt_u32 s15, 524288
    s_sleep 1
    s_cbranch_scc1 Lw_18
Lw_18_ok:
    global_store_dwordx4 v6, v[2:5], s[42:43] sc1
    s_mov_b64 exec, 0xffffff
    global_store_dwordx4 v6, v[2:5], s[42:43] offset:1024 sc1
    s_waitcnt vmcnt(0)
    s_mov_b64 exec, 1
    v_mov_b32 v1, 1
    ds_add_rtn_u32 v1, v15, v1 offset:44
    s_waitcnt lgkmcnt(0)
    v_readfirstlane_b32 s9, v1
    s_nop 0
    s_cmp_eq_u32 s9, 7
    s_cbranch_scc0 Lnotlast
    s_add_u32 s9, s7, 1
    s_lshl_b32 s10, s4, 4
    s_add_u32 s10, s10, 16384
    v_mov_b32 v2, s10
    v_mov_b32 v3, s9
    global_store_dword v2, v3, s[42:43] sc1
Lnotlast:
    s_mov_b64 exec, -1
Lnosent:
    s_cmp_eq_u32 s3, 0
    s_cbranch_scc0 Lnowarm
    s_mov_b64 exec, 0
    s_branch Lpad_S_0
Lret_S:
    s_mov_b64 exec, -1
Lnowarm:
    s_cmp_eq_u32 s5, 2
    s_cselect_b32 s9, 0, 0
    s_cmp_lt_u32 s3, s9
    s_cbranch_scc0 Lhold
    s_mov_b32 s15, 0
Lw_19:
    ds_read_b32 v1, v15 offset:20
    s_waitcnt lgkmcnt(0)
    v_readfirstlane_b32 s9, v1
    s_nop 0
    s_cmp_ge_u32 s9, 8
    s_cbranch_scc1 Lw_19_ok
    s_add_u32 s15, s15, 1
    s_cmp_lt_u32 s15, 524288
    s_sleep 1
    s_cbranch_scc1 Lw_19
Lw_19_ok:
    s_branch Lkv2
Lhold:
    s_mov_b32 s15, 0
Lw_20:
    ds_read_b32 v1, v15 offset:28
    s_waitcnt lgkmcnt(0)
    v_readfirstlane_b32 s9, v1
    s_nop 0
    s_cmp_ge_u32 s9, 8
    s_cbranch_scc1 Lw_20_ok
    s_add_u32 s15, s15, 1
    s_cmp_lt_u32 s15, 524288
    s_sleep 1
    s_cbranch_scc1 Lw_20
Lw_20_ok:
    s_branch Lkv2
Lworker:
Lpad_S_0:
    s_cbranch_execz Lpad_S_1
    s_load_dwordx8 s[24:31], s[0:1], 32
    s_load_dwordx2 s[32:33], s[0:1], 64
    s_load_dword s7, s[42:43], 0
    s_mov_b64 exec, 1
    v_mov_b32 v1, 1
    ds_add_u32 v15, v1 offset:20
    s_mov_b64 exec, -1
    v_bfe_u32 v1, v0, 2, 2
    v_lshrrev_b32 v100, 4, v0
    v_lshl_add_u32 v100, v1, 2, v100
    v_lshlrev_b32 v100, 7, v100
    v_lshl_add_u32 v100, v1, 5, v100
    v_and_b32 v1, 3, v0
    v_lshl_add_u32 v100, v1, 3, v100
    v_add_u32 v100, s12, v100
    v_xor_b32 v101, 32, v100
    v_xor_b32 v102, 64, v100
    v_xor_b32 v103, 96, v100
    s_lshr_b32 s9, s14, 2
    s_lshl_b32 s9, s9, 10
    s_and_b32 s62, s14, 3
    s_lshl_b32 s62, s62, 2
    s_add_u32 s9, s9, s62
    v_add_u32 v14, 108032, v11
    v_add_u32 v13, s9, v14
    s_mov_b32 s66, 0xffff0000
    s_mov_b32 s67, 0xffff0000
    s_mov_b32 s68, 0
    s_mov_b32 s69, -1
    s_waitcnt lgkmcnt(0)
    s_add_u32 s7, s7, 1
    s_cmp_eq_u32 s63, 2
    s_cbranch_scc1 LF2
    s_lshl_b32 s11, s13, 8
    s_add_u32 s11, s11, 4096
    s_cmp_eq_u32 s14, 0
    s_cselect_b32 s64, 1, 0
    s_waitcnt vmcnt(8)
    v_mov_b32 v48, v56
    v_lshlrev_b32 v48, 16, v48
    v_mul_f32 v49, 0xbfb8aa3b, v48
    v_min_f32 v49, 0x42fc0000, v49
    v_exp_f32 v49, v49
    s_nop 0
    v_add_f32 v49, 1.0, v49
    v_rcp_f32 v50, v49
    s_nop 0
    v_mul_f32 v56, v48, v50
    v_fma_f32 v48, -v56, v49, v48
    v_fmac_f32 v56, v48, v50
    s_waitcnt vmcnt(0)
    ds_read_b64_tr_b16 v[16:17], v100 offset:0
    ds_read_b64_tr_b16 v[18:19], v100 offset:2048
    ds_read_b64_tr_b16 v[20:21], v101 offset:0
    ds_read_b64_tr_b16 v[22:23], v101 offset:2048
    ds_read_b64_tr_b16 v[24:25], v102 offset:0
    ds_read_b64_tr_b16 v[26:27], v102 offset:2048
    ds_read_b64_tr_b16 v[28:29], v103 offset:0
    ds_read_b64_tr_b16 v[30:31], v103 offset:2048
    ds_read_b64_tr_b16 v[32:33], v100 offset:4096
    ds_read_b64_tr_b16 v[34:35], v100 offset:6144
Lpad_S_1:
    s_cbranch_execz Lpad_S_2
    ds_read_b64_tr_b16 v[36:37], v101 offset:4096
    ds_read_b64_tr_b16 v[38:39], v101 offset:6144
    ds_read_b64_tr_b16 v[40:41], v102 offset:4096
    ds_read_b64_tr_b16 v[42:43], v102 offset:6144
    ds_read_b64_tr_b16 v[44:45], v103 offset:4096
    ds_read_b64_tr_b16 v[46:47], v103 offset:6144
    s_branch Lmv
LF2:
    s_lshr_b32 s11, s13, 1
    s_lshl_b32 s11, s11, 3
    s_add_u32 s11, s11, s14
    s_lshl_b32 s11, s11, 9
    s_and_b32 s9, s13, 1
    s_lshl_b32 s9, s9, 8
    s_add_u32 s11, s11, s9
    s_add_u32 s11, s11, 524288
    s_mov_b32 s64, 1
    v_lshlrev_b32 v5, 2, v12
    v_and_b32 v5, -8, v5
    v_add_u32 v5, 4096, v5
    s_waitcnt vmcnt(8)
    v_lshlrev_b32 v60, 16, v52
    v_and_b32 v61, 0xffff0000, v52
    v_lshlrev_b32 v62, 16, v53
    v_and_b32 v63, 0xffff0000, v53
    v_lshlrev_b32 v64, 16, v54
    v_and_b32 v65, 0xffff0000, v54
    v_lshlrev_b32 v66, 16, v55
    v_and_b32 v67, 0xffff0000, v55
    v_add_f32 v2, v60, v61
    v_add_f32 v3, v62, v63
    v_add_f32 v4, v64, v65
    v_add_f32 v57, v66, v67
    v_add_f32 v2, v2, v3
    v_add_f32 v4, v4, v57
    v_add_f32 v2, v2, v4
    s_nop 1
    v_add_f32_dpp v2, v2, v2 row_ror:1 row_mask:0xf bank_mask:0xf
    s_nop 1
    v_add_f32_dpp v2, v2, v2 row_ror:2 row_mask:0xf bank_mask:0xf
    s_nop 1
    v_add_f32_dpp v2, v2, v2 row_ror:4 row_mask:0xf bank_mask:0xf
    s_nop 1
    v_add_f32_dpp v2, v2, v2 row_ror:8 row_mask:0xf bank_mask:0xf
    v_mov_b32 v3, v2
    s_nop 1
    v_permlane16_swap_b32 v2, v3
    v_add_f32 v2, v2, v3
    v_mov_b32 v3, v2
    s_nop 1
    v_permlane32_swap_b32 v2, v3
    v_add_f32 v2, v2, v3
    v_mul_f32 v2, 0x3b000000, v2
    v_sub_f32 v60, v60, v2
    v_sub_f32 v61, v61, v2
    v_sub_f32 v62, v62, v2
    v_sub_f32 v63, v63, v2
    v_sub_f32 v64, v64, v2
    v_sub_f32 v65, v65, v2
    v_sub_f32 v66, v66, v2
    v_sub_f32 v67, v67, v2
    v_mul_f32 v4, v60, v60
    v_fmac_f32 v4, v61, v61
    v_fmac_f32 v4, v62, v62
    v_fmac_f32 v4, v63, v63
    v_fmac_f32 v4, v64, v64
    v_fmac_f32 v4, v65, v65
    v_fmac_f32 v4, v66, v66
    v_fmac_f32 v4, v67, v67
    s_nop 1
    v_add_f32_dpp v4, v4, v4 row_ror:1 row_mask:0xf bank_mask:0xf
    s_nop 1
    v_add_f32_dpp v4, v4, v4 row_ror:2 row_mask:0xf bank_mask:0xf
    s_nop 1
    v_add_f32_dpp v4, v4, v4 row_ror:4 row_mask:0xf bank_mask:0xf
    s_nop 1
    v_add_f32_dpp v4, v4, v4 row_ror:8 row_mask:0xf bank_mask:0xf
    v_mov_b32 v3, v4
    s_nop 1
    v_permlane16_swap_b32 v4, v3
    v_add_f32 v4, v4, v3
    v_mov_b32 v3, v4
    s_nop 1
    v_permlane32_swap_b32 v4, v3
    v_add_f32 v4, v4, v3
    v_mul_f32 v4, 0x3b000000, v4
    v_cvt_pk_bf16_f32 v4, 0, v4
    v_cvt_pk_bf16_f32 v2, 0, v2
    v_add_f32 v4, 0x3727c5ac, v4
    v_cvt_pk_bf16_f32 v4, 0, v4
    v_sqrt_f32 v4, v4
    s_nop 0
    v_cvt_pk_bf16_f32 v4, 0, v4
    v_rcp_f32 v4, v4
    v_lshlrev_b32 v56, 16, v56
    v_sub_f32 v56, v56, v2
    v_cvt_pk_bf16_f32 v56, 0, v56
    v_mul_f32 v56, v56, v4
    v_cvt_pk_bf16_f32 v56, 0, v56
    s_waitcnt vmcnt(0)
    ds_read_b64_tr_b16 v[16:17], v100 offset:0
    ds_read_b64_tr_b16 v[18:19], v100 offset:2048
    ds_read_b64_tr_b16 v[20:21], v101 offset:0
    ds_read_b64_tr_b16 v[22:23], v101 offset:2048
    ds_read_b64_tr_b16 v[24:25], v102 offset:0
    ds_read_b64_tr_b16 v[26:27], v102 offset:2048
    ds_read_b64_tr_b16 v[28:29], v103 offset:0
    ds_read_b64_tr_b16 v[30:31], v103 offset:2048
    ds_read_b64_tr_b16 v[32:33], v100 offset:4096
    ds_read_b64_tr_b16 v[34:35], v100 offset:6144
    ds_read_b64_tr_b16 v[36:37], v101 offset:4096
    ds_read_b64_tr_b16 v[38:39], v101 offset:6144
    ds_read_b64_tr_b16 v[40:41], v102 offset:4096
    ds_read_b64_tr_b16 v[42:43], v102 offset:6144
    ds_read_b64_tr_b16 v[44:45], v103 offset:4096
    ds_read_b64_tr_b16 v[46:47], v103 offset:6144
    s_mov_b32 s15, 0
Lpoll_21:
    global_load_dwordx2 v[96:97], v5, s[42:43] sc1
    global_load_dwordx2 v[98:99], v5, s[42:43] offset:2048 sc1
    s_waitcnt vmcnt(0)
    v_xor_b32 v2, s7, v97
    v_xor_b32 v3, s7, v99
    v_or_b32 v2, v2, v3
    v_cmp_ne_u32 vcc, 0, v2
    s_nop 0
    s_and_b64 exec, exec, vcc
    s_cbranch_scc0 Lpoll_21_ok
    s_add_u32 s15, s15, 1
    s_cmp_lt_u32 s15, 131072
    s_sleep 1
    s_cbranch_scc1 Lpoll_21
Lpoll_21_ok:
    s_mov_b64 exec, -1
    v_lshlrev_b32 v62, v7, v98
    v_and_b32 v62, 0xffff0000, v62
    v_add_f32 v62, 1.0, v62
    v_cvt_pk_bf16_f32 v62, 0, v62
    v_mul_f32 v56, v56, v62
    v_cvt_pk_bf16_f32 v56, 0, v56
    v_lshlrev_b32 v60, v7, v96
    v_and_b32 v60, 0xffff0000, v60
    v_add_f32 v56, v56, v60
Lmv:
    s_nop 1
    v_mov_b32_dpp v73, v56 row_shl:1 row_mask:0xf bank_mask:0xf
    v_cvt_pk_bf16_f32 v56, v56, v73
    s_nop 1
    v_mov_b32_dpp v72, v56 row_newbcast:0 row_mask:0xf bank_mask:0xf
    v_mov_b32_dpp v73, v56 row_newbcast:2 row_mask:0xf bank_mask:0xf
    v_mov_b32_dpp v74, v56 row_newbcast:4 row_mask:0xf bank_mask:0xf
    v_mov_b32_dpp v75, v56 row_newbcast:6 row_mask:0xf bank_mask:0xf
    v_mov_b32_dpp v76, v56 row_newbcast:8 row_mask:0xf bank_mask:0xf
    v_mov_b32_dpp v77, v56 row_newbcast:10 row_mask:0xf bank_mask:0xf
    v_mov_b32_dpp v78, v56 row_newbcast:12 row_mask:0xf bank_mask:0xf
    v_mov_b32_dpp v79, v56 row_newbcast:14 row_mask:0xf bank_mask:0xf
    s_waitcnt lgkmcnt(0)
    v_mfma_f32_16x16x32_bf16 v[80:83], v[72:75], v[16:19], 0
    v_mfma_f32_16x16x32_bf16 v[84:87], v[72:75], v[20:23], 0
    v_mfma_f32_16x16x32_bf16 v[88:91], v[72:75], v[24:27], 0
    v_mfma_f32_16x16x32_bf16 v[92:95], v[72:75], v[28:31], 0
    v_mfma_f32_16x16x32_bf16 v[80:83], v[76:79], v[32:35], v[80:83]
    v_mfma_f32_16x16x32_bf16 v[84:87], v[76:79], v[36:39], v[84:87]
    v_mfma_f32_16x16x32_bf16 v[88:91], v[76:79], v[40:43], v[88:91]
    v_mfma_f32_16x16x32_bf16 v[92:95], v[76:79], v[44:47], v[92:95]
    v_mov_b32 v1, 1
    s_nop 4
    v_cndmask_b32 v80, v80, v84, s[66:67]
    s_nop 0
    v_cndmask_b32 v88, v88, v92, s[66:67]
    v_cndmask_b32 v80, v80, v88, s[68:69]
    ds_write_b32 v13, v80 offset:2048
    s_mov_b64 exec, 1
    ds_add_u32 v15, v1 offset:24
    s_mov_b64 exec, -1
    s_cmp_eq_u32 s64, 0
    s_cbranch_scc1 Lmvdone
    v_lshl_add_u32 v6, v0, 2, s11
    v_mov_b32 v69, s7
    s_mov_b32 s15, 0
Lw_22:
    ds_read_b32 v1, v15 offset:24
    s_waitcnt lgkmcnt(0)
Lpad_S_2:
    s_cbranch_execz Lret_S
    v_readfirstlane_b32 s9, v1
    s_nop 0
    s_cmp_ge_u32 s9, 8
    s_cbranch_scc1 Lw_22_ok
    s_add_u32 s15, s15, 1
    s_cmp_lt_u32 s15, 524288
    s_cbranch_scc1 Lw_22
Lw_22_ok:
    ds_read_b128 v[60:63], v14 offset:2048
    ds_read_b128 v[64:67], v14 offset:3072
    s_waitcnt lgkmcnt(0)
    v_pk_add_f32 v[60:61], v[60:61], v[64:65]
    v_pk_add_f32 v[62:63], v[62:63], v[66:67]
    v_pk_add_f32 v[60:61], v[60:61], v[62:63]
    v_add_f32 v60, v60, v61
    s_nop 1
    v_mov_b32_dpp v61, v60 row_shl:1 row_mask:0xf bank_mask:0xf
    v_cvt_pk_bf16_f32 v68, v60, v61
    s_mov_b32 exec_lo, 0x55555555
    s_mov_b32 exec_hi, 0x55555555
    global_store_dwordx2 v6, v[68:69], s[42:43] sc1
Lmvdone:
    s_mov_b64 exec, 1
    v_mov_b32 v1, 1
    ds_add_u32 v15, v1 offset:28
    s_mov_b64 exec, -1
    s_branch Lhold
Lexit:
    s_endpgm
.section .rodata,"a"
.p2align 6
.amdhsa_kernel adaLN_cond__gqa_block_cached__glu_gated_bilinear__decode_kernel
  .amdhsa_next_free_vgpr 128
  .amdhsa_next_free_sgpr 102
  .amdhsa_accum_offset 128
  .amdhsa_group_segment_fixed_size 0
  .amdhsa_kernarg_size 112
  .amdhsa_user_sgpr_count 2
  .amdhsa_user_sgpr_kernarg_segment_ptr 1
  .amdhsa_system_sgpr_workgroup_id_x 1
  .amdhsa_float_denorm_mode_32 3
.end_amdhsa_kernel
```
